```python
import torch

def _softmax(x, axis=-1):
    return torch.softmax(x, dim=axis)
def _gelu(x):
    return torch.nn.functional.gelu(x, approximate="tanh")
def _silu(x):
    return torch.nn.functional.silu(x)
def _sigmoid(x):
    return torch.sigmoid(x)
def _layernorm(x, axis=-1, eps=1e-5):
    m = x.mean(dim=axis, keepdim=True)
    v = x.var(dim=axis, keepdim=True, unbiased=False)
    return (x - m) / torch.sqrt(v + eps)
def _scatter_add(tgt, idx, src, axis=0):
    return tgt.clone().index_add_(axis, idx, src)
def _segment_sum(src, seg, n):
    out = torch.zeros((n,) + src.shape[1:], dtype=src.dtype)
    return out.index_add_(0, seg, src)
def _pad(x, pw):
    flat = tuple(v for pair in reversed(pw) for v in pair)
    return torch.nn.functional.pad(x, flat)

kernel_name = 'standalone__gqa_block_cached__sampling'

def setup_inputs():

    _w = (lambda a: (lambda t: t.to(torch.bfloat16) if t.is_floating_point() else t)(torch.as_tensor(a)))
    B, Sq, D = 8, 4, 448
    Hq, Hkv, Sk, Dh = 16, 8, 8192, 256
    assert Hq % Hkv == 0, (Hq, Hkv)
    return {
        "x": _w((lambda *s: torch.randn(*s, dtype=torch.bfloat16) * 0.8)(B, Sq, D)),
        "k_cache": _w((lambda *s: torch.randn(*s, dtype=torch.bfloat16) * 0.8)(B, Hkv, Sk, Dh)),
        "v_cache": _w((lambda *s: torch.randn(*s, dtype=torch.bfloat16) * 0.05)(B, Hkv, Sk, Dh)),
        "wq": _w((lambda *s: torch.randn(*s, dtype=torch.bfloat16) * 0.8)(D, Hq * Dh) * (D ** -0.5)),
        "wo": _w((lambda *s: torch.randn(*s, dtype=torch.bfloat16) * 0.05)(Hq * Dh, D) * ((Hq * Dh) ** -0.5)),
    }

def reference(x, k_cache, v_cache, wq, wo):
    B, Sq, D = x.shape
    Hq, Dh = 16, 256
    Hkv = k_cache.shape[1]
    rep = Hq // Hkv
    q = (lambda x, *d: x.permute(*d))((x @ wq).reshape(B, Sq, Hq, Dh), 0, 2, 1, 3)
    k = (lambda x, n, axis: torch.repeat_interleave(x, n, dim=axis))(k_cache, rep, axis=1)
    v = (lambda x, n, axis: torch.repeat_interleave(x, n, dim=axis))(v_cache, rep, axis=1)
    scores = torch.einsum("bhqd,bhkd->bhqk", q, k) * (Dh ** -0.5)
    p = _softmax(scores, axis=-1)
    o = torch.einsum("bhqk,bhkd->bhqd", p, v)
    return (lambda x, *d: x.permute(*d))(o, 0, 2, 1, 3).reshape(B, Sq, Hq * Dh) @ wo
```

```asm
; @launch grid=(256,1,1) block=(256,1,1) lds=161920
.amdgcn_target "amdgcn-amd-amdhsa--gfx950"
.text
.globl standalone__gqa_block_cached__sampling_kernel
.p2align 8
.type standalone__gqa_block_cached__sampling_kernel,@function
standalone__gqa_block_cached__sampling_kernel:
    s_cmp_ge_u32 s2, 256
    s_cbranch_scc1 L_end
    s_load_dwordx16 s[4:19], s[0:1], 0
    v_lshrrev_b32 v1, 6, v0
    v_and_b32 v0, 63, v0
    v_readfirstlane_b32 s3, v1
    s_lshr_b32 s40, s2, 2
    s_and_b32 s41, s2, 3
    s_lshr_b32 s42, s2, 5
    s_and_b32 s43, s40, 7
    s_lshl_b32 s73, s40, 2
    s_add_u32 s73, s73, s41
    s_lshl_b32 s44, s40, 22
    s_waitcnt lgkmcnt(0)
    s_add_u32 s20, s6, s44
    s_addc_u32 s21, s7, 0
    s_mov_b32 s22, 0x400000
    s_mov_b32 s23, 0x20000
    s_add_u32 s24, s8, s44
    s_addc_u32 s25, s9, 0
    s_mov_b32 s26, 0x400000
    s_mov_b32 s27, 0x20000
    s_load_dword s84, s[18:19], 0x80000
    s_mov_b32 s28, s18
    s_mov_b32 s29, s19
    s_mov_b32 s30, 12582912
    s_mov_b32 s31, 0x20000
    s_cmp_eq_u32 s3, 1
    s_cbranch_scc1 L_w1
    s_cmp_eq_u32 s3, 2
    s_cbranch_scc1 L_w2
    s_cmp_eq_u32 s3, 3
    s_cbranch_scc1 L_w3
L_w0:
    v_and_b32 v1, 15, v0
    v_lshrrev_b32 v14, 4, v0
    v_lshlrev_b32 v2, 9, v1
    v_lshl_add_u32 v2, v14, 4, v2
    v_add_u32 v3, 8192, v2
    s_mov_b32 s45, 81920
    s_lshl_b32 s47, s41, 20
    s_add_u32 m0, s45, 0
    s_nop 0
    buffer_load_dwordx4 v2, s[20:23], s47 offen offset:0 nt lds
    s_add_u32 m0, s45, 960
    s_nop 0
    buffer_load_dwordx4 v2, s[20:23], s47 offen offset:64 nt lds
    s_add_u32 m0, s45, 1920
    s_nop 0
    buffer_load_dwordx4 v2, s[20:23], s47 offen offset:128 nt lds
    s_add_u32 m0, s45, 2880
    s_nop 0
    buffer_load_dwordx4 v2, s[20:23], s47 offen offset:192 nt lds
    s_add_u32 m0, s45, 3840
    s_nop 0
    buffer_load_dwordx4 v2, s[20:23], s47 offen offset:256 nt lds
    s_add_u32 m0, s45, 4800
    s_nop 0
    buffer_load_dwordx4 v2, s[20:23], s47 offen offset:320 nt lds
    s_add_u32 m0, s45, 5760
    s_nop 0
    buffer_load_dwordx4 v2, s[20:23], s47 offen offset:384 nt lds
    s_add_u32 m0, s45, 6720
    s_nop 0
    buffer_load_dwordx4 v2, s[20:23], s47 offen offset:448 nt lds
    s_add_u32 m0, s45, 8192
    s_nop 0
    buffer_load_dwordx4 v3, s[20:23], s47 offen offset:0 nt lds
    s_add_u32 m0, s45, 9152
    s_nop 0
    buffer_load_dwordx4 v3, s[20:23], s47 offen offset:64 nt lds
    s_add_u32 m0, s45, 10112
    s_nop 0
    buffer_load_dwordx4 v3, s[20:23], s47 offen offset:128 nt lds
    s_add_u32 m0, s45, 11072
    s_nop 0
    buffer_load_dwordx4 v3, s[20:23], s47 offen offset:192 nt lds
    s_add_u32 m0, s45, 12032
    s_nop 0
    buffer_load_dwordx4 v3, s[20:23], s47 offen offset:256 nt lds
    s_add_u32 m0, s45, 12992
    s_nop 0
    buffer_load_dwordx4 v3, s[20:23], s47 offen offset:320 nt lds
    s_add_u32 m0, s45, 13952
    s_nop 0
    buffer_load_dwordx4 v3, s[20:23], s47 offen offset:384 nt lds
    s_add_u32 m0, s45, 14912
    s_nop 0
    buffer_load_dwordx4 v3, s[20:23], s47 offen offset:448 nt lds
    v_lshlrev_b32 v15, 1, v14
    v_xor_b32 v15, v15, v1
    v_lshlrev_b32 v15, 4, v15
    v_lshl_add_u32 v4, v14, 9, v15
    v_add_u32 v6, 4096, v4
    v_add_u32 v8, 8192, v4
    v_add_u32 v10, 12288, v4
    v_lshlrev_b32 v15, 1, v14
    v_add_u32 v15, 8, v15
    v_xor_b32 v15, v15, v1
    v_lshlrev_b32 v15, 4, v15
    v_lshl_add_u32 v5, v14, 9, v15
    v_add_u32 v7, 4096, v5
    v_add_u32 v9, 8192, v5
    v_add_u32 v11, 12288, v5
    v_mov_b32 v12, 161792
    s_mov_b32 s44, 1
    s_mov_b32 s45, 98304
    s_mov_b32 s46, 0
    s_mov_b32 s48, s47
    s_add_u32 s47, s47, 16384
    s_add_u32 m0, s45, 0
    s_nop 0
    buffer_load_dwordx4 v2, s[20:23], s47 offen offset:0 nt lds
    s_add_u32 m0, s46, 0
    s_nop 0
    buffer_load_dwordx4 v4, s[24:27], s48 offen offset:0 nt lds
    s_add_u32 m0, s45, 960
    s_nop 0
    buffer_load_dwordx4 v2, s[20:23], s47 offen offset:64 nt lds
    s_add_u32 m0, s46, 768
    s_nop 0
    buffer_load_dwordx4 v4, s[24:27], s48 offen offset:256 nt lds
    s_add_u32 m0, s45, 1920
    s_nop 0
    buffer_load_dwordx4 v2, s[20:23], s47 offen offset:128 nt lds
    s_add_u32 m0, s46, 0
    s_nop 0
    buffer_load_dwordx4 v5, s[24:27], s48 offen offset:2048 nt lds
    s_add_u32 m0, s45, 2880
    s_nop 0
    buffer_load_dwordx4 v2, s[20:23], s47 offen offset:192 nt lds
    s_add_u32 m0, s46, 768
    s_nop 0
    buffer_load_dwordx4 v5, s[24:27], s48 offen offset:2304 nt lds
    s_add_u32 m0, s45, 3840
    s_nop 0
    buffer_load_dwordx4 v2, s[20:23], s47 offen offset:256 nt lds
    s_add_u32 m0, s46, 4096
    s_nop 0
    buffer_load_dwordx4 v6, s[24:27], s48 offen offset:0 nt lds
    s_barrier
    s_waitcnt lgkmcnt(0)
    s_add_u32 m0, s45, 4800
    s_waitcnt vmcnt(25)
    buffer_load_dwordx4 v2, s[20:23], s47 offen offset:320 nt lds
    s_add_u32 m0, s46, 4864
    s_waitcnt vmcnt(25)
    buffer_load_dwordx4 v6, s[24:27], s48 offen offset:256 nt lds
    s_add_u32 m0, s45, 5760
    s_waitcnt vmcnt(25)
    buffer_load_dwordx4 v2, s[20:23], s47 offen offset:384 nt lds
    s_add_u32 m0, s46, 4096
    s_waitcnt vmcnt(25)
    buffer_load_dwordx4 v7, s[24:27], s48 offen offset:2048 nt lds
    s_add_u32 m0, s45, 6720
    s_waitcnt vmcnt(25)
    buffer_load_dwordx4 v2, s[20:23], s47 offen offset:448 nt lds
    s_add_u32 m0, s46, 4864
    s_waitcnt vmcnt(25)
    buffer_load_dwordx4 v7, s[24:27], s48 offen offset:2304 nt lds
    s_add_u32 m0, s45, 8192
    s_waitcnt vmcnt(25)
    buffer_load_dwordx4 v3, s[20:23], s47 offen offset:0 nt lds
    s_add_u32 m0, s46, 8192
    s_waitcnt vmcnt(25)
    buffer_load_dwordx4 v8, s[24:27], s48 offen offset:0 nt lds
    s_add_u32 m0, s45, 9152
    s_waitcnt vmcnt(25)
    buffer_load_dwordx4 v3, s[20:23], s47 offen offset:64 nt lds
    s_add_u32 m0, s46, 8960
    s_waitcnt vmcnt(25)
    buffer_load_dwordx4 v8, s[24:27], s48 offen offset:256 nt lds
    s_add_u32 m0, s45, 10112
    s_waitcnt vmcnt(25)
    buffer_load_dwordx4 v3, s[20:23], s47 offen offset:128 nt lds
    s_add_u32 m0, s46, 8192
    s_waitcnt vmcnt(25)
    buffer_load_dwordx4 v9, s[24:27], s48 offen offset:2048 nt lds
    s_add_u32 m0, s45, 11072
    s_waitcnt vmcnt(25)
    buffer_load_dwordx4 v3, s[20:23], s47 offen offset:192 nt lds
    s_add_u32 m0, s46, 8960
    s_waitcnt vmcnt(25)
    buffer_load_dwordx4 v9, s[24:27], s48 offen offset:2304 nt lds
    s_add_u32 m0, s45, 12032
    s_waitcnt vmcnt(25)
    buffer_load_dwordx4 v3, s[20:23], s47 offen offset:256 nt lds
    s_add_u32 m0, s46, 12288
    s_waitcnt vmcnt(25)
    v_mov_b32 v13, 1
    s_mov_b64 exec, 1
    ds_write_b32 v12, v13 offset:0
    s_mov_b64 exec, -1
    buffer_load_dwordx4 v10, s[24:27], s48 offen offset:0 nt lds
    s_add_u32 m0, s45, 12992
    s_waitcnt vmcnt(25)
    buffer_load_dwordx4 v3, s[20:23], s47 offen offset:320 nt lds
    s_add_u32 m0, s46, 13056
    s_waitcnt vmcnt(25)
    buffer_load_dwordx4 v10, s[24:27], s48 offen offset:256 nt lds
    s_add_u32 m0, s45, 13952
    s_waitcnt vmcnt(25)
    buffer_load_dwordx4 v3, s[20:23], s47 offen offset:384 nt lds
    s_add_u32 m0, s46, 12288
    s_waitcnt vmcnt(25)
    buffer_load_dwordx4 v11, s[24:27], s48 offen offset:2048 nt lds
    s_add_u32 m0, s45, 14912
    s_waitcnt vmcnt(25)
    buffer_load_dwordx4 v3, s[20:23], s47 offen offset:448 nt lds
    s_add_u32 m0, s46, 13056
    s_waitcnt vmcnt(25)
    buffer_load_dwordx4 v11, s[24:27], s48 offen offset:2304 nt lds
    s_add_u32 s44, s44, 1
    s_add_u32 s45, s45, 16384
    s_cmp_eq_u32 s45, 147456
    s_cselect_b32 s45, 65536, s45
    s_add_u32 s46, s46, 16384
    s_cmp_eq_u32 s46, 65536
    s_cselect_b32 s46, 0, s46
    s_mov_b32 s48, s47
    s_add_u32 s47, s47, 16384
    s_add_u32 m0, s45, 0
    s_waitcnt vmcnt(25)
    buffer_load_dwordx4 v2, s[20:23], s47 offen offset:0 nt lds
    s_add_u32 m0, s46, 0
    s_waitcnt vmcnt(25)
    buffer_load_dwordx4 v4, s[24:27], s48 offen offset:0 nt lds
    s_add_u32 m0, s45, 960
    s_waitcnt vmcnt(25)
    buffer_load_dwordx4 v2, s[20:23], s47 offen offset:64 nt lds
    s_add_u32 m0, s46, 768
    s_waitcnt vmcnt(25)
    buffer_load_dwordx4 v4, s[24:27], s48 offen offset:256 nt lds
    s_add_u32 m0, s45, 1920
    s_waitcnt vmcnt(25)
    buffer_load_dwordx4 v2, s[20:23], s47 offen offset:128 nt lds
    s_add_u32 m0, s46, 0
    s_waitcnt vmcnt(25)
    buffer_load_dwordx4 v5, s[24:27], s48 offen offset:2048 nt lds
    s_add_u32 m0, s45, 2880
    s_waitcnt vmcnt(25)
    buffer_load_dwordx4 v2, s[20:23], s47 offen offset:192 nt lds
    s_add_u32 m0, s46, 768
    s_waitcnt vmcnt(25)
    buffer_load_dwordx4 v5, s[24:27], s48 offen offset:2304 nt lds
    s_add_u32 m0, s45, 3840
    s_waitcnt vmcnt(25)
    buffer_load_dwordx4 v2, s[20:23], s47 offen offset:256 nt lds
    s_add_u32 m0, s46, 4096
    s_waitcnt vmcnt(25)
    buffer_load_dwordx4 v6, s[24:27], s48 offen offset:0 nt lds
    s_add_u32 m0, s45, 4800
    s_waitcnt vmcnt(25)
    buffer_load_dwordx4 v2, s[20:23], s47 offen offset:320 nt lds
    s_add_u32 m0, s46, 4864
    s_waitcnt vmcnt(25)
    buffer_load_dwordx4 v6, s[24:27], s48 offen offset:256 nt lds
    s_add_u32 m0, s45, 5760
    s_waitcnt vmcnt(25)
    buffer_load_dwordx4 v2, s[20:23], s47 offen offset:384 nt lds
    s_add_u32 m0, s46, 4096
    s_waitcnt vmcnt(25)
    buffer_load_dwordx4 v7, s[24:27], s48 offen offset:2048 nt lds
    s_add_u32 m0, s45, 6720
    s_waitcnt vmcnt(25)
    buffer_load_dwordx4 v2, s[20:23], s47 offen offset:448 nt lds
    s_add_u32 m0, s46, 4864
    s_waitcnt vmcnt(25)
    buffer_load_dwordx4 v7, s[24:27], s48 offen offset:2304 nt lds
    s_add_u32 m0, s45, 8192
    s_waitcnt vmcnt(25)
    buffer_load_dwordx4 v3, s[20:23], s47 offen offset:0 nt lds
    s_add_u32 m0, s46, 8192
    s_waitcnt vmcnt(25)
    buffer_load_dwordx4 v8, s[24:27], s48 offen offset:0 nt lds
    s_add_u32 m0, s45, 9152
    s_waitcnt vmcnt(25)
    buffer_load_dwordx4 v3, s[20:23], s47 offen offset:64 nt lds
    s_add_u32 m0, s46, 8960
    s_waitcnt vmcnt(25)
    buffer_load_dwordx4 v8, s[24:27], s48 offen offset:256 nt lds
    s_add_u32 m0, s45, 10112
    s_waitcnt vmcnt(25)
    buffer_load_dwordx4 v3, s[20:23], s47 offen offset:128 nt lds
    s_add_u32 m0, s46, 8192
    s_waitcnt vmcnt(25)
    buffer_load_dwordx4 v9, s[24:27], s48 offen offset:2048 nt lds
    s_add_u32 m0, s45, 11072
    s_waitcnt vmcnt(25)
    buffer_load_dwordx4 v3, s[20:23], s47 offen offset:192 nt lds
    s_add_u32 m0, s46, 8960
    s_waitcnt vmcnt(25)
    buffer_load_dwordx4 v9, s[24:27], s48 offen offset:2304 nt lds
    s_add_u32 m0, s45, 12032
    s_waitcnt vmcnt(25)
    buffer_load_dwordx4 v3, s[20:23], s47 offen offset:256 nt lds
    s_add_u32 m0, s46, 12288
    s_waitcnt vmcnt(25)
    v_mov_b32 v13, 2
    s_mov_b64 exec, 1
    ds_write_b32 v12, v13 offset:0
    s_mov_b64 exec, -1
    buffer_load_dwordx4 v10, s[24:27], s48 offen offset:0 nt lds
    s_add_u32 m0, s45, 12992
    s_waitcnt vmcnt(25)
    buffer_load_dwordx4 v3, s[20:23], s47 offen offset:320 nt lds
    s_add_u32 m0, s46, 13056
    s_waitcnt vmcnt(25)
    buffer_load_dwordx4 v10, s[24:27], s48 offen offset:256 nt lds
    s_add_u32 m0, s45, 13952
    s_waitcnt vmcnt(25)
    buffer_load_dwordx4 v3, s[20:23], s47 offen offset:384 nt lds
    s_add_u32 m0, s46, 12288
    s_waitcnt vmcnt(25)
    buffer_load_dwordx4 v11, s[24:27], s48 offen offset:2048 nt lds
    s_add_u32 m0, s45, 14912
    s_waitcnt vmcnt(25)
    buffer_load_dwordx4 v3, s[20:23], s47 offen offset:448 nt lds
    s_add_u32 m0, s46, 13056
    s_waitcnt vmcnt(25)
    buffer_load_dwordx4 v11, s[24:27], s48 offen offset:2304 nt lds
    s_add_u32 s44, s44, 1
    s_add_u32 s45, s45, 16384
    s_cmp_eq_u32 s45, 147456
    s_cselect_b32 s45, 65536, s45
    s_add_u32 s46, s46, 16384
    s_cmp_eq_u32 s46, 65536
    s_cselect_b32 s46, 0, s46
    s_mov_b32 s48, s47
    s_add_u32 s47, s47, 16384
    s_add_u32 m0, s45, 0
    s_waitcnt vmcnt(25)
    buffer_load_dwordx4 v2, s[20:23], s47 offen offset:0 nt lds
    s_add_u32 m0, s46, 0
    s_waitcnt vmcnt(25)
    buffer_load_dwordx4 v4, s[24:27], s48 offen offset:0 nt lds
    s_add_u32 m0, s45, 960
    s_waitcnt vmcnt(25)
    buffer_load_dwordx4 v2, s[20:23], s47 offen offset:64 nt lds
    s_add_u32 m0, s46, 768
    s_waitcnt vmcnt(25)
    buffer_load_dwordx4 v4, s[24:27], s48 offen offset:256 nt lds
    s_add_u32 m0, s45, 1920
    s_waitcnt vmcnt(25)
    buffer_load_dwordx4 v2, s[20:23], s47 offen offset:128 nt lds
    s_add_u32 m0, s46, 0
    s_waitcnt vmcnt(25)
    buffer_load_dwordx4 v5, s[24:27], s48 offen offset:2048 nt lds
    s_add_u32 m0, s45, 2880
    s_waitcnt vmcnt(25)
    buffer_load_dwordx4 v2, s[20:23], s47 offen offset:192 nt lds
    s_add_u32 m0, s46, 768
    s_waitcnt vmcnt(25)
    buffer_load_dwordx4 v5, s[24:27], s48 offen offset:2304 nt lds
    s_add_u32 m0, s45, 3840
    s_waitcnt vmcnt(25)
    buffer_load_dwordx4 v2, s[20:23], s47 offen offset:256 nt lds
    s_add_u32 m0, s46, 4096
    s_waitcnt vmcnt(25)
    buffer_load_dwordx4 v6, s[24:27], s48 offen offset:0 nt lds
    s_add_u32 m0, s45, 4800
    s_waitcnt vmcnt(25)
    buffer_load_dwordx4 v2, s[20:23], s47 offen offset:320 nt lds
    s_add_u32 m0, s46, 4864
    s_waitcnt vmcnt(25)
    buffer_load_dwordx4 v6, s[24:27], s48 offen offset:256 nt lds
    s_add_u32 m0, s45, 5760
    s_waitcnt vmcnt(25)
    buffer_load_dwordx4 v2, s[20:23], s47 offen offset:384 nt lds
    s_add_u32 m0, s46, 4096
    s_waitcnt vmcnt(25)
    buffer_load_dwordx4 v7, s[24:27], s48 offen offset:2048 nt lds
    s_add_u32 m0, s45, 6720
    s_waitcnt vmcnt(25)
    buffer_load_dwordx4 v2, s[20:23], s47 offen offset:448 nt lds
    s_add_u32 m0, s46, 4864
    s_waitcnt vmcnt(25)
    buffer_load_dwordx4 v7, s[24:27], s48 offen offset:2304 nt lds
    s_add_u32 m0, s45, 8192
    s_waitcnt vmcnt(25)
    buffer_load_dwordx4 v3, s[20:23], s47 offen offset:0 nt lds
    s_add_u32 m0, s46, 8192
    s_waitcnt vmcnt(25)
    buffer_load_dwordx4 v8, s[24:27], s48 offen offset:0 nt lds
    s_add_u32 m0, s45, 9152
    s_waitcnt vmcnt(25)
    buffer_load_dwordx4 v3, s[20:23], s47 offen offset:64 nt lds
    s_add_u32 m0, s46, 8960
    s_waitcnt vmcnt(25)
    buffer_load_dwordx4 v8, s[24:27], s48 offen offset:256 nt lds
    s_add_u32 m0, s45, 10112
    s_waitcnt vmcnt(25)
    buffer_load_dwordx4 v3, s[20:23], s47 offen offset:128 nt lds
    s_add_u32 m0, s46, 8192
    s_waitcnt vmcnt(25)
    buffer_load_dwordx4 v9, s[24:27], s48 offen offset:2048 nt lds
    s_add_u32 m0, s45, 11072
    s_waitcnt vmcnt(25)
    buffer_load_dwordx4 v3, s[20:23], s47 offen offset:192 nt lds
    s_add_u32 m0, s46, 8960
    s_waitcnt vmcnt(25)
    buffer_load_dwordx4 v9, s[24:27], s48 offen offset:2304 nt lds
    s_add_u32 m0, s45, 12032
    s_waitcnt vmcnt(25)
    buffer_load_dwordx4 v3, s[20:23], s47 offen offset:256 nt lds
    s_add_u32 m0, s46, 12288
    s_waitcnt vmcnt(25)
    v_mov_b32 v13, 3
    s_mov_b64 exec, 1
    ds_write_b32 v12, v13 offset:0
    s_mov_b64 exec, -1
    buffer_load_dwordx4 v10, s[24:27], s48 offen offset:0 nt lds
    s_add_u32 m0, s45, 12992
    s_waitcnt vmcnt(25)
    buffer_load_dwordx4 v3, s[20:23], s47 offen offset:320 nt lds
    s_add_u32 m0, s46, 13056
    s_waitcnt vmcnt(25)
    buffer_load_dwordx4 v10, s[24:27], s48 offen offset:256 nt lds
    s_add_u32 m0, s45, 13952
    s_waitcnt vmcnt(25)
    buffer_load_dwordx4 v3, s[20:23], s47 offen offset:384 nt lds
    s_add_u32 m0, s46, 12288
    s_waitcnt vmcnt(25)
    buffer_load_dwordx4 v11, s[24:27], s48 offen offset:2048 nt lds
    s_add_u32 m0, s45, 14912
    s_waitcnt vmcnt(25)
    buffer_load_dwordx4 v3, s[20:23], s47 offen offset:448 nt lds
    s_add_u32 m0, s46, 13056
    s_waitcnt vmcnt(25)
    buffer_load_dwordx4 v11, s[24:27], s48 offen offset:2304 nt lds
    s_add_u32 s44, s44, 1
    s_add_u32 s45, s45, 16384
    s_cmp_eq_u32 s45, 147456
    s_cselect_b32 s45, 65536, s45
    s_add_u32 s46, s46, 16384
    s_cmp_eq_u32 s46, 65536
    s_cselect_b32 s46, 0, s46
    s_mov_b32 s48, s47
    s_add_u32 s47, s47, 16384
    s_mov_b32 s52, 262144
L_fpoll_1:
    ds_read_b32 v13, v12 offset:32
    s_sub_u32 s52, s52, 1
    s_cbranch_scc1 L_fskip_2
    s_waitcnt lgkmcnt(0)
    v_readfirstlane_b32 s50, v13
    s_cmp_ge_u32 s50, 1
    s_cbranch_scc1 L_fskip_2
    s_sleep 1
    s_branch L_fpoll_1
L_fskip_2:
    s_add_u32 m0, s45, 0
    s_waitcnt vmcnt(25)
    buffer_load_dwordx4 v2, s[20:23], s47 offen offset:0 nt lds
    s_add_u32 m0, s46, 0
    s_waitcnt vmcnt(25)
    buffer_load_dwordx4 v4, s[24:27], s48 offen offset:0 nt lds
    s_add_u32 m0, s45, 960
    s_waitcnt vmcnt(25)
    buffer_load_dwordx4 v2, s[20:23], s47 offen offset:64 nt lds
    s_add_u32 m0, s46, 768
    s_waitcnt vmcnt(25)
    buffer_load_dwordx4 v4, s[24:27], s48 offen offset:256 nt lds
    s_add_u32 m0, s45, 1920
    s_waitcnt vmcnt(25)
    buffer_load_dwordx4 v2, s[20:23], s47 offen offset:128 nt lds
    s_add_u32 m0, s46, 0
    s_waitcnt vmcnt(25)
    buffer_load_dwordx4 v5, s[24:27], s48 offen offset:2048 nt lds
    s_add_u32 m0, s45, 2880
    s_waitcnt vmcnt(25)
    buffer_load_dwordx4 v2, s[20:23], s47 offen offset:192 nt lds
    s_add_u32 m0, s46, 768
    s_waitcnt vmcnt(25)
    buffer_load_dwordx4 v5, s[24:27], s48 offen offset:2304 nt lds
    s_add_u32 m0, s45, 3840
    s_waitcnt vmcnt(25)
    buffer_load_dwordx4 v2, s[20:23], s47 offen offset:256 nt lds
    s_add_u32 m0, s46, 4096
    s_waitcnt vmcnt(25)
    buffer_load_dwordx4 v6, s[24:27], s48 offen offset:0 nt lds
    s_add_u32 m0, s45, 4800
    s_waitcnt vmcnt(25)
    buffer_load_dwordx4 v2, s[20:23], s47 offen offset:320 nt lds
    s_add_u32 m0, s46, 4864
    s_waitcnt vmcnt(25)
    buffer_load_dwordx4 v6, s[24:27], s48 offen offset:256 nt lds
    s_add_u32 m0, s45, 5760
    s_waitcnt vmcnt(25)
    buffer_load_dwordx4 v2, s[20:23], s47 offen offset:384 nt lds
    s_add_u32 m0, s46, 4096
    s_waitcnt vmcnt(25)
    buffer_load_dwordx4 v7, s[24:27], s48 offen offset:2048 nt lds
    s_add_u32 m0, s45, 6720
    s_waitcnt vmcnt(25)
    buffer_load_dwordx4 v2, s[20:23], s47 offen offset:448 nt lds
    s_add_u32 m0, s46, 4864
    s_waitcnt vmcnt(25)
    buffer_load_dwordx4 v7, s[24:27], s48 offen offset:2304 nt lds
    s_add_u32 m0, s45, 8192
    s_waitcnt vmcnt(25)
    buffer_load_dwordx4 v3, s[20:23], s47 offen offset:0 nt lds
    s_add_u32 m0, s46, 8192
    s_waitcnt vmcnt(25)
    buffer_load_dwordx4 v8, s[24:27], s48 offen offset:0 nt lds
    s_add_u32 m0, s45, 9152
    s_waitcnt vmcnt(25)
    buffer_load_dwordx4 v3, s[20:23], s47 offen offset:64 nt lds
    s_add_u32 m0, s46, 8960
    s_waitcnt vmcnt(25)
    buffer_load_dwordx4 v8, s[24:27], s48 offen offset:256 nt lds
    s_add_u32 m0, s45, 10112
    s_waitcnt vmcnt(25)
    buffer_load_dwordx4 v3, s[20:23], s47 offen offset:128 nt lds
    s_add_u32 m0, s46, 8192
    s_waitcnt vmcnt(25)
    buffer_load_dwordx4 v9, s[24:27], s48 offen offset:2048 nt lds
    s_add_u32 m0, s45, 11072
    s_waitcnt vmcnt(25)
    buffer_load_dwordx4 v3, s[20:23], s47 offen offset:192 nt lds
    s_add_u32 m0, s46, 8960
    s_waitcnt vmcnt(25)
    buffer_load_dwordx4 v9, s[24:27], s48 offen offset:2304 nt lds
    s_add_u32 m0, s45, 12032
    s_waitcnt vmcnt(25)
    buffer_load_dwordx4 v3, s[20:23], s47 offen offset:256 nt lds
    s_add_u32 m0, s46, 12288
    s_waitcnt vmcnt(25)
    v_mov_b32 v13, 4
    s_mov_b64 exec, 1
    ds_write_b32 v12, v13 offset:0
    s_mov_b64 exec, -1
    buffer_load_dwordx4 v10, s[24:27], s48 offen offset:0 nt lds
    s_add_u32 m0, s45, 12992
    s_waitcnt vmcnt(25)
    buffer_load_dwordx4 v3, s[20:23], s47 offen offset:320 nt lds
    s_add_u32 m0, s46, 13056
    s_waitcnt vmcnt(25)
    buffer_load_dwordx4 v10, s[24:27], s48 offen offset:256 nt lds
    s_add_u32 m0, s45, 13952
    s_waitcnt vmcnt(25)
    buffer_load_dwordx4 v3, s[20:23], s47 offen offset:384 nt lds
    s_add_u32 m0, s46, 12288
    s_waitcnt vmcnt(25)
    buffer_load_dwordx4 v11, s[24:27], s48 offen offset:2048 nt lds
    s_add_u32 m0, s45, 14912
    s_waitcnt vmcnt(25)
    buffer_load_dwordx4 v3, s[20:23], s47 offen offset:448 nt lds
    s_add_u32 m0, s46, 13056
    s_waitcnt vmcnt(25)
    buffer_load_dwordx4 v11, s[24:27], s48 offen offset:2304 nt lds
    s_add_u32 s44, s44, 1
    s_add_u32 s45, s45, 16384
    s_cmp_eq_u32 s45, 147456
    s_cselect_b32 s45, 65536, s45
    s_add_u32 s46, s46, 16384
    s_cmp_eq_u32 s46, 65536
    s_cselect_b32 s46, 0, s46
    s_mov_b32 s48, s47
    s_add_u32 s47, s47, 16384
    s_waitcnt lgkmcnt(0)
    s_add_u32 s85, s84, 0x9e3779b9
    v_mov_b32 v16, s85
    v_mov_b32 v18, 0
    s_nop 0
    v_readfirstlane_b32 s62, v16
    s_nop 0
    v_readfirstlane_b32 s64, v16
    s_mov_b32 s66, 0xfffff000
    s_and_b32 s65, s64, 0xfff
    s_lshl_b32 s63, s40, 7
    s_add_u32 s63, s63, 589824
    s_and_b32 s62, s62, 0xffffff00
    s_sub_u32 s67, 56, s44
L_ld_loop:
    s_cmp_lg_u32 s67, 0
    s_cbranch_scc1 L_ld_static
L_ld_ticket:
    v_readfirstlane_b32 s60, v17
    s_and_b32 s61, s60, 0xffffff00
    s_cmp_lg_u32 s61, s62
    s_cbranch_scc1 L_ld_retry
    s_and_b32 s60, s60, 0xff
    s_cmp_ge_u32 s60, 16
    s_cbranch_scc1 L_ld_last
    s_lshr_b32 s61, s60, 2
    s_lshl_b32 s61, s61, 3
    s_lshr_b32 s67, 0x1010204, s61
    s_and_b32 s67, s67, 0xff
    s_lshr_b32 s61, 0x7060400, s61
    s_and_b32 s61, s61, 0xff
    s_and_b32 s60, s60, 3
    s_lshl_b32 s60, s60, 6
    s_add_u32 s60, s60, s61
    s_add_u32 s60, s60, 56
    s_lshl_b32 s47, s60, 14
L_ld_static:
    s_sub_u32 s67, s67, 1
    s_cmp_lg_u32 s67, 0
    s_cbranch_scc1 L_ld_notk
    v_mov_b32 v17, 1
    s_mov_b64 exec, 1
    buffer_atomic_add v17, v18, s[28:31], s63 offen sc0
    s_mov_b64 exec, -1
L_ld_notk:
    s_sub_u32 s49, s44, 3
    s_mov_b32 s52, 262144
L_fpoll_3:
    ds_read_b32 v13, v12 offset:64
    s_sub_u32 s52, s52, 1
    s_cbranch_scc1 L_fskip_4
    s_waitcnt lgkmcnt(0)
    v_readfirstlane_b32 s50, v13
    s_cmp_ge_u32 s50, s49
    s_cbranch_scc1 L_fskip_4
    s_sleep 1
    s_branch L_fpoll_3
L_fskip_4:
    s_add_u32 m0, s45, 0
    s_waitcnt vmcnt(25)
    buffer_load_dwordx4 v2, s[20:23], s47 offen offset:0 nt lds
    s_add_u32 m0, s46, 0
    s_waitcnt vmcnt(25)
    buffer_load_dwordx4 v4, s[24:27], s48 offen offset:0 nt lds
    s_add_u32 m0, s45, 960
    s_waitcnt vmcnt(25)
    buffer_load_dwordx4 v2, s[20:23], s47 offen offset:64 nt lds
    s_add_u32 m0, s46, 768
    s_waitcnt vmcnt(25)
    buffer_load_dwordx4 v4, s[24:27], s48 offen offset:256 nt lds
    s_add_u32 m0, s45, 1920
    s_waitcnt vmcnt(25)
    buffer_load_dwordx4 v2, s[20:23], s47 offen offset:128 nt lds
    s_add_u32 m0, s46, 0
    s_waitcnt vmcnt(25)
    buffer_load_dwordx4 v5, s[24:27], s48 offen offset:2048 nt lds
    s_add_u32 m0, s45, 2880
    s_waitcnt vmcnt(25)
    buffer_load_dwordx4 v2, s[20:23], s47 offen offset:192 nt lds
    s_add_u32 m0, s46, 768
    s_waitcnt vmcnt(25)
    buffer_load_dwordx4 v5, s[24:27], s48 offen offset:2304 nt lds
    s_add_u32 m0, s45, 3840
    s_waitcnt vmcnt(25)
    buffer_load_dwordx4 v2, s[20:23], s47 offen offset:256 nt lds
    s_add_u32 m0, s46, 4096
    s_waitcnt vmcnt(25)
    buffer_load_dwordx4 v6, s[24:27], s48 offen offset:0 nt lds
    s_add_u32 m0, s45, 4800
    s_waitcnt vmcnt(25)
    buffer_load_dwordx4 v2, s[20:23], s47 offen offset:320 nt lds
    s_add_u32 m0, s46, 4864
    s_waitcnt vmcnt(25)
    buffer_load_dwordx4 v6, s[24:27], s48 offen offset:256 nt lds
    s_add_u32 m0, s45, 5760
    s_waitcnt vmcnt(25)
    buffer_load_dwordx4 v2, s[20:23], s47 offen offset:384 nt lds
    s_add_u32 m0, s46, 4096
    s_waitcnt vmcnt(25)
    buffer_load_dwordx4 v7, s[24:27], s48 offen offset:2048 nt lds
    s_add_u32 m0, s45, 6720
    s_waitcnt vmcnt(25)
    buffer_load_dwordx4 v2, s[20:23], s47 offen offset:448 nt lds
    s_add_u32 m0, s46, 4864
    s_waitcnt vmcnt(25)
    buffer_load_dwordx4 v7, s[24:27], s48 offen offset:2304 nt lds
    s_add_u32 m0, s45, 8192
    s_waitcnt vmcnt(25)
    buffer_load_dwordx4 v3, s[20:23], s47 offen offset:0 nt lds
    s_add_u32 m0, s46, 8192
    s_waitcnt vmcnt(25)
    buffer_load_dwordx4 v8, s[24:27], s48 offen offset:0 nt lds
    s_add_u32 m0, s45, 9152
    s_waitcnt vmcnt(25)
    buffer_load_dwordx4 v3, s[20:23], s47 offen offset:64 nt lds
    s_add_u32 m0, s46, 8960
    s_waitcnt vmcnt(25)
    buffer_load_dwordx4 v8, s[24:27], s48 offen offset:256 nt lds
    s_add_u32 m0, s45, 10112
    s_waitcnt vmcnt(25)
    buffer_load_dwordx4 v3, s[20:23], s47 offen offset:128 nt lds
    s_add_u32 m0, s46, 8192
    s_waitcnt vmcnt(25)
    buffer_load_dwordx4 v9, s[24:27], s48 offen offset:2048 nt lds
    s_add_u32 m0, s45, 11072
    s_waitcnt vmcnt(25)
    buffer_load_dwordx4 v3, s[20:23], s47 offen offset:192 nt lds
    s_add_u32 m0, s46, 8960
    s_waitcnt vmcnt(25)
    buffer_load_dwordx4 v9, s[24:27], s48 offen offset:2304 nt lds
    s_add_u32 m0, s45, 12032
    s_waitcnt vmcnt(25)
    buffer_load_dwordx4 v3, s[20:23], s47 offen offset:256 nt lds
    s_add_u32 m0, s46, 12288
    s_waitcnt vmcnt(25)
    v_mov_b32 v13, s44
    s_mov_b64 exec, 1
    ds_write_b32 v12, v13 offset:0
    s_mov_b64 exec, -1
    buffer_load_dwordx4 v10, s[24:27], s48 offen offset:0 nt lds
    s_add_u32 m0, s45, 12992
    s_waitcnt vmcnt(25)
    buffer_load_dwordx4 v3, s[20:23], s47 offen offset:320 nt lds
    s_add_u32 m0, s46, 13056
    s_waitcnt vmcnt(25)
    buffer_load_dwordx4 v10, s[24:27], s48 offen offset:256 nt lds
    s_add_u32 m0, s45, 13952
    s_waitcnt vmcnt(25)
    buffer_load_dwordx4 v3, s[20:23], s47 offen offset:384 nt lds
    s_add_u32 m0, s46, 12288
    s_waitcnt vmcnt(25)
    buffer_load_dwordx4 v11, s[24:27], s48 offen offset:2048 nt lds
    s_add_u32 m0, s45, 14912
    s_waitcnt vmcnt(25)
    buffer_load_dwordx4 v3, s[20:23], s47 offen offset:448 nt lds
    s_add_u32 m0, s46, 13056
    s_waitcnt vmcnt(25)
    buffer_load_dwordx4 v11, s[24:27], s48 offen offset:2304 nt lds
    s_add_u32 s44, s44, 1
    s_add_u32 s45, s45, 16384
    s_cmp_eq_u32 s45, 147456
    s_cselect_b32 s45, 65536, s45
    s_add_u32 s46, s46, 16384
    s_cmp_eq_u32 s46, 65536
    s_cselect_b32 s46, 0, s46
    s_mov_b32 s48, s47
    s_add_u32 s47, s47, 16384
    s_branch L_ld_loop
L_ld_retry:
    s_mov_b32 s52, 262144
L_ld_retry2:
    v_mov_b32 v17, 1
    s_mov_b64 exec, 1
    buffer_atomic_add v17, v18, s[28:31], s63 offen sc0
    s_mov_b64 exec, -1
    s_waitcnt vmcnt(0)
    v_readfirstlane_b32 s60, v17
    s_and_b32 s61, s60, 0xffffff00
    s_cmp_eq_u32 s61, s62
    s_cbranch_scc1 L_ld_ticket
    s_sleep 8
    s_sub_u32 s52, s52, 1
    s_cbranch_scc0 L_ld_retry2
L_ld_last:
    v_mov_b32 v13, s44
    s_mov_b64 exec, 1
    ds_write_b32 v12, v13 offset:4
    s_mov_b64 exec, -1
    s_sub_u32 s49, s44, 3
    s_mov_b32 s52, 262144
L_fpoll_5:
    ds_read_b32 v13, v12 offset:64
    s_sub_u32 s52, s52, 1
    s_cbranch_scc1 L_fskip_6
    s_waitcnt lgkmcnt(0)
    v_readfirstlane_b32 s50, v13
    s_cmp_ge_u32 s50, s49
    s_cbranch_scc1 L_fskip_6
    s_sleep 1
    s_branch L_fpoll_5
L_fskip_6:
    s_add_u32 m0, s46, 0
    s_waitcnt vmcnt(25)
    buffer_load_dwordx4 v4, s[24:27], s48 offen offset:0 nt lds
    s_add_u32 m0, s46, 0
    s_waitcnt vmcnt(25)
    buffer_load_dwordx4 v5, s[24:27], s48 offen offset:2048 nt lds
    s_add_u32 m0, s46, 4096
    s_waitcnt vmcnt(25)
    buffer_load_dwordx4 v6, s[24:27], s48 offen offset:0 nt lds
    s_add_u32 m0, s46, 4096
    s_waitcnt vmcnt(25)
    buffer_load_dwordx4 v7, s[24:27], s48 offen offset:2048 nt lds
    s_add_u32 m0, s46, 8192
    s_waitcnt vmcnt(25)
    buffer_load_dwordx4 v8, s[24:27], s48 offen offset:0 nt lds
    s_add_u32 m0, s46, 8192
    s_waitcnt vmcnt(25)
    buffer_load_dwordx4 v9, s[24:27], s48 offen offset:2048 nt lds
    s_add_u32 m0, s46, 12288
    s_waitcnt vmcnt(25)
    buffer_load_dwordx4 v10, s[24:27], s48 offen offset:0 nt lds
    s_add_u32 m0, s46, 12288
    s_waitcnt vmcnt(25)
    buffer_load_dwordx4 v11, s[24:27], s48 offen offset:2048 nt lds
    s_add_u32 m0, s46, 768
    s_waitcnt vmcnt(25)
    buffer_load_dwordx4 v4, s[24:27], s48 offen offset:256 nt lds
    s_add_u32 m0, s46, 768
    s_waitcnt vmcnt(25)
    buffer_load_dwordx4 v5, s[24:27], s48 offen offset:2304 nt lds
    s_add_u32 m0, s46, 4864
    s_waitcnt vmcnt(25)
    buffer_load_dwordx4 v6, s[24:27], s48 offen offset:256 nt lds
    s_add_u32 m0, s46, 4864
    s_waitcnt vmcnt(25)
    buffer_load_dwordx4 v7, s[24:27], s48 offen offset:2304 nt lds
    s_add_u32 m0, s46, 8960
    s_waitcnt vmcnt(25)
    buffer_load_dwordx4 v8, s[24:27], s48 offen offset:256 nt lds
    s_add_u32 m0, s46, 8960
    s_waitcnt vmcnt(25)
    buffer_load_dwordx4 v9, s[24:27], s48 offen offset:2304 nt lds
    s_add_u32 m0, s46, 13056
    s_waitcnt vmcnt(25)
    buffer_load_dwordx4 v10, s[24:27], s48 offen offset:256 nt lds
    s_add_u32 m0, s46, 13056
    s_waitcnt vmcnt(25)
    buffer_load_dwordx4 v11, s[24:27], s48 offen offset:2304 nt lds
    v_mov_b32 v13, 1
    s_mov_b64 exec, 1
    ds_write_b32 v12, v13 offset:96
    s_mov_b64 exec, -1
    s_mov_b32 s32, s12
    s_mov_b32 s33, s13
    s_mov_b32 s34, 3670016
    s_mov_b32 s35, 0x20000
    s_lshl_b32 s56, s43, 2
    s_add_u32 s56, s56, s41
    s_mul_i32 s56, s56, 114688
    s_mul_i32 s53, s3, 224
    s_add_u32 s56, s56, s53
    v_lshrrev_b32 v60, 4, v0
    v_mul_u32_u24 v60, 3584, v60
    v_and_b32 v61, 15, v0
    v_lshl_add_u32 v60, v61, 4, v60
    s_mov_b32 s54, 0x05040100
    s_mov_b32 s55, 0x07060302
    s_waitcnt vmcnt(16)
    v_mov_b32 v13, s44
    s_mov_b64 exec, 1
    ds_write_b32 v12, v13 offset:0
    s_mov_b64 exec, -1
    s_add_u32 s53, s56, 0
    buffer_load_dwordx4 v[64:67], v60, s[32:35], s53 offen
    s_add_u32 s53, s56, 896
    buffer_load_dwordx4 v[68:71], v60, s[32:35], s53 offen
    s_add_u32 s53, s56, 1792
    buffer_load_dwordx4 v[72:75], v60, s[32:35], s53 offen
    s_add_u32 s53, s56, 2688
    buffer_load_dwordx4 v[76:79], v60, s[32:35], s53 offen
    s_add_u32 s53, s56, 14336
    buffer_load_dwordx4 v[80:83], v60, s[32:35], s53 offen
    s_add_u32 s53, s56, 15232
    buffer_load_dwordx4 v[84:87], v60, s[32:35], s53 offen
    s_add_u32 s53, s56, 16128
    buffer_load_dwordx4 v[88:91], v60, s[32:35], s53 offen
    s_add_u32 s53, s56, 17024
    buffer_load_dwordx4 v[92:95], v60, s[32:35], s53 offen
    s_add_u32 s53, s56, 28672
    buffer_load_dwordx4 v[96:99], v60, s[32:35], s53 offen
    s_add_u32 s53, s56, 29568
    buffer_load_dwordx4 v[100:103], v60, s[32:35], s53 offen
    s_add_u32 s53, s56, 30464
    buffer_load_dwordx4 v[104:107], v60, s[32:35], s53 offen
    s_add_u32 s53, s56, 31360
    buffer_load_dwordx4 v[108:111], v60, s[32:35], s53 offen
    s_add_u32 s53, s56, 43008
    buffer_load_dwordx4 v[112:115], v60, s[32:35], s53 offen
    s_add_u32 s53, s56, 43904
    buffer_load_dwordx4 v[116:119], v60, s[32:35], s53 offen
    s_add_u32 s53, s56, 44800
    buffer_load_dwordx4 v[120:123], v60, s[32:35], s53 offen
    s_add_u32 s53, s56, 45696
    buffer_load_dwordx4 v[124:127], v60, s[32:35], s53 offen
    s_add_u32 s53, s56, 57344
    buffer_load_dwordx4 v[128:131], v60, s[32:35], s53 offen
    s_add_u32 s53, s56, 58240
    buffer_load_dwordx4 v[132:135], v60, s[32:35], s53 offen
    s_add_u32 s53, s56, 59136
    buffer_load_dwordx4 v[136:139], v60, s[32:35], s53 offen
    s_add_u32 s53, s56, 60032
    buffer_load_dwordx4 v[140:143], v60, s[32:35], s53 offen
    s_add_u32 s53, s56, 71680
    buffer_load_dwordx4 v[144:147], v60, s[32:35], s53 offen
    s_add_u32 s53, s56, 72576
    buffer_load_dwordx4 v[148:151], v60, s[32:35], s53 offen
    s_add_u32 s53, s56, 73472
    buffer_load_dwordx4 v[152:155], v60, s[32:35], s53 offen
    s_add_u32 s53, s56, 74368
    buffer_load_dwordx4 v[156:159], v60, s[32:35], s53 offen
    s_add_u32 s53, s56, 86016
    buffer_load_dwordx4 v[160:163], v60, s[32:35], s53 offen
    s_add_u32 s53, s56, 86912
    buffer_load_dwordx4 v[164:167], v60, s[32:35], s53 offen
    s_add_u32 s53, s56, 87808
    buffer_load_dwordx4 v[168:171], v60, s[32:35], s53 offen
    s_add_u32 s53, s56, 88704
    buffer_load_dwordx4 v[172:175], v60, s[32:35], s53 offen
    s_add_u32 s53, s56, 100352
    buffer_load_dwordx4 v[176:179], v60, s[32:35], s53 offen
    s_add_u32 s53, s56, 101248
    buffer_load_dwordx4 v[180:183], v60, s[32:35], s53 offen
    s_add_u32 s53, s56, 102144
    buffer_load_dwordx4 v[184:187], v60, s[32:35], s53 offen
    s_add_u32 s53, s56, 103040
    buffer_load_dwordx4 v[188:191], v60, s[32:35], s53 offen
    s_waitcnt vmcnt(40)
    v_mov_b32 v13, 1
    s_mov_b64 exec, 1
    ds_write_b32 v12, v13 offset:40
    s_mov_b64 exec, -1
    s_waitcnt vmcnt(32)
    s_add_u32 s44, s44, 1
    v_mov_b32 v13, s44
    s_mov_b64 exec, 1
    ds_write_b32 v12, v13 offset:0
    s_mov_b64 exec, -1
    s_waitcnt vmcnt(24)
    v_perm_b32 v56, v68, v64, s54
    v_accvgpr_write_b32 a32, v56
    v_perm_b32 v57, v76, v72, s54
    v_accvgpr_write_b32 a33, v57
    v_perm_b32 v58, v84, v80, s54
    v_accvgpr_write_b32 a34, v58
    v_perm_b32 v59, v92, v88, s54
    v_accvgpr_write_b32 a35, v59
    v_perm_b32 v56, v68, v64, s55
    v_accvgpr_write_b32 a48, v56
    v_perm_b32 v57, v76, v72, s55
    v_accvgpr_write_b32 a49, v57
    v_perm_b32 v58, v84, v80, s55
    v_accvgpr_write_b32 a50, v58
    v_perm_b32 v59, v92, v88, s55
    v_accvgpr_write_b32 a51, v59
    v_perm_b32 v56, v69, v65, s54
    v_accvgpr_write_b32 a64, v56
    v_perm_b32 v57, v77, v73, s54
    v_accvgpr_write_b32 a65, v57
    v_perm_b32 v58, v85, v81, s54
    v_accvgpr_write_b32 a66, v58
    v_perm_b32 v59, v93, v89, s54
    v_accvgpr_write_b32 a67, v59
    v_perm_b32 v56, v69, v65, s55
    v_accvgpr_write_b32 a80, v56
    v_perm_b32 v57, v77, v73, s55
    v_accvgpr_write_b32 a81, v57
    v_perm_b32 v58, v85, v81, s55
    v_accvgpr_write_b32 a82, v58
    v_perm_b32 v59, v93, v89, s55
    v_accvgpr_write_b32 a83, v59
    v_perm_b32 v56, v70, v66, s54
    v_accvgpr_write_b32 a96, v56
    v_perm_b32 v57, v78, v74, s54
    v_accvgpr_write_b32 a97, v57
    v_perm_b32 v58, v86, v82, s54
    v_accvgpr_write_b32 a98, v58
    v_perm_b32 v59, v94, v90, s54
    v_accvgpr_write_b32 a99, v59
    v_perm_b32 v56, v70, v66, s55
    v_accvgpr_write_b32 a112, v56
    v_perm_b32 v57, v78, v74, s55
    v_accvgpr_write_b32 a113, v57
    v_perm_b32 v58, v86, v82, s55
    v_accvgpr_write_b32 a114, v58
    v_perm_b32 v59, v94, v90, s55
    v_accvgpr_write_b32 a115, v59
    v_perm_b32 v56, v71, v67, s54
    v_accvgpr_write_b32 a128, v56
    v_perm_b32 v57, v79, v75, s54
    v_accvgpr_write_b32 a129, v57
    v_perm_b32 v58, v87, v83, s54
    v_accvgpr_write_b32 a130, v58
    v_perm_b32 v59, v95, v91, s54
    v_accvgpr_write_b32 a131, v59
    v_perm_b32 v56, v71, v67, s55
    v_accvgpr_write_b32 a144, v56
    v_perm_b32 v57, v79, v75, s55
    v_accvgpr_write_b32 a145, v57
    v_perm_b32 v58, v87, v83, s55
    v_accvgpr_write_b32 a146, v58
    v_perm_b32 v59, v95, v91, s55
    v_accvgpr_write_b32 a147, v59
    s_waitcnt vmcnt(16)
    v_perm_b32 v56, v100, v96, s54
    v_accvgpr_write_b32 a36, v56
    v_perm_b32 v57, v108, v104, s54
    v_accvgpr_write_b32 a37, v57
    v_perm_b32 v58, v116, v112, s54
    v_accvgpr_write_b32 a38, v58
    v_perm_b32 v59, v124, v120, s54
    v_accvgpr_write_b32 a39, v59
    v_perm_b32 v56, v100, v96, s55
    v_accvgpr_write_b32 a52, v56
    v_perm_b32 v57, v108, v104, s55
    v_accvgpr_write_b32 a53, v57
    v_perm_b32 v58, v116, v112, s55
    v_accvgpr_write_b32 a54, v58
    v_perm_b32 v59, v124, v120, s55
    v_accvgpr_write_b32 a55, v59
    v_perm_b32 v56, v101, v97, s54
    v_accvgpr_write_b32 a68, v56
    v_perm_b32 v57, v109, v105, s54
    v_accvgpr_write_b32 a69, v57
    v_perm_b32 v58, v117, v113, s54
    v_accvgpr_write_b32 a70, v58
    v_perm_b32 v59, v125, v121, s54
    v_accvgpr_write_b32 a71, v59
    v_perm_b32 v56, v101, v97, s55
    v_accvgpr_write_b32 a84, v56
    v_perm_b32 v57, v109, v105, s55
    v_accvgpr_write_b32 a85, v57
    v_perm_b32 v58, v117, v113, s55
    v_accvgpr_write_b32 a86, v58
    v_perm_b32 v59, v125, v121, s55
    v_accvgpr_write_b32 a87, v59
    v_perm_b32 v56, v102, v98, s54
    v_accvgpr_write_b32 a100, v56
    v_perm_b32 v57, v110, v106, s54
    v_accvgpr_write_b32 a101, v57
    v_perm_b32 v58, v118, v114, s54
    v_accvgpr_write_b32 a102, v58
    v_perm_b32 v59, v126, v122, s54
    v_accvgpr_write_b32 a103, v59
    v_perm_b32 v56, v102, v98, s55
    v_accvgpr_write_b32 a116, v56
    v_perm_b32 v57, v110, v106, s55
    v_accvgpr_write_b32 a117, v57
    v_perm_b32 v58, v118, v114, s55
    v_accvgpr_write_b32 a118, v58
    v_perm_b32 v59, v126, v122, s55
    v_accvgpr_write_b32 a119, v59
    v_perm_b32 v56, v103, v99, s54
    v_accvgpr_write_b32 a132, v56
    v_perm_b32 v57, v111, v107, s54
    v_accvgpr_write_b32 a133, v57
    v_perm_b32 v58, v119, v115, s54
    v_accvgpr_write_b32 a134, v58
    v_perm_b32 v59, v127, v123, s54
    v_accvgpr_write_b32 a135, v59
    v_perm_b32 v56, v103, v99, s55
    v_accvgpr_write_b32 a148, v56
    v_perm_b32 v57, v111, v107, s55
    v_accvgpr_write_b32 a149, v57
    v_perm_b32 v58, v119, v115, s55
    v_accvgpr_write_b32 a150, v58
    v_perm_b32 v59, v127, v123, s55
    v_accvgpr_write_b32 a151, v59
    s_waitcnt vmcnt(8)
    v_perm_b32 v56, v132, v128, s54
    v_accvgpr_write_b32 a40, v56
    v_perm_b32 v57, v140, v136, s54
    v_accvgpr_write_b32 a41, v57
    v_perm_b32 v58, v148, v144, s54
    v_accvgpr_write_b32 a42, v58
    v_perm_b32 v59, v156, v152, s54
    v_accvgpr_write_b32 a43, v59
    v_perm_b32 v56, v132, v128, s55
    v_accvgpr_write_b32 a56, v56
    v_perm_b32 v57, v140, v136, s55
    v_accvgpr_write_b32 a57, v57
    v_perm_b32 v58, v148, v144, s55
    v_accvgpr_write_b32 a58, v58
    v_perm_b32 v59, v156, v152, s55
    v_accvgpr_write_b32 a59, v59
    v_perm_b32 v56, v133, v129, s54
    v_accvgpr_write_b32 a72, v56
    v_perm_b32 v57, v141, v137, s54
    v_accvgpr_write_b32 a73, v57
    v_perm_b32 v58, v149, v145, s54
    v_accvgpr_write_b32 a74, v58
    v_perm_b32 v59, v157, v153, s54
    v_accvgpr_write_b32 a75, v59
    v_perm_b32 v56, v133, v129, s55
    v_accvgpr_write_b32 a88, v56
    v_perm_b32 v57, v141, v137, s55
    v_accvgpr_write_b32 a89, v57
    v_perm_b32 v58, v149, v145, s55
    v_accvgpr_write_b32 a90, v58
    v_perm_b32 v59, v157, v153, s55
    v_accvgpr_write_b32 a91, v59
    v_perm_b32 v56, v134, v130, s54
    v_accvgpr_write_b32 a104, v56
    v_perm_b32 v57, v142, v138, s54
    v_accvgpr_write_b32 a105, v57
    v_perm_b32 v58, v150, v146, s54
    v_accvgpr_write_b32 a106, v58
    v_perm_b32 v59, v158, v154, s54
    v_accvgpr_write_b32 a107, v59
    v_perm_b32 v56, v134, v130, s55
    v_accvgpr_write_b32 a120, v56
    v_perm_b32 v57, v142, v138, s55
    v_accvgpr_write_b32 a121, v57
    v_perm_b32 v58, v150, v146, s55
    v_accvgpr_write_b32 a122, v58
    v_perm_b32 v59, v158, v154, s55
    v_accvgpr_write_b32 a123, v59
    v_perm_b32 v56, v135, v131, s54
    v_accvgpr_write_b32 a136, v56
    v_perm_b32 v57, v143, v139, s54
    v_accvgpr_write_b32 a137, v57
    v_perm_b32 v58, v151, v147, s54
    v_accvgpr_write_b32 a138, v58
    v_perm_b32 v59, v159, v155, s54
    v_accvgpr_write_b32 a139, v59
    v_perm_b32 v56, v135, v131, s55
    v_accvgpr_write_b32 a152, v56
    v_perm_b32 v57, v143, v139, s55
    v_accvgpr_write_b32 a153, v57
    v_perm_b32 v58, v151, v147, s55
    v_accvgpr_write_b32 a154, v58
    v_perm_b32 v59, v159, v155, s55
    v_accvgpr_write_b32 a155, v59
    s_waitcnt vmcnt(0)
    v_perm_b32 v56, v164, v160, s54
    v_accvgpr_write_b32 a44, v56
    v_perm_b32 v57, v172, v168, s54
    v_accvgpr_write_b32 a45, v57
    v_perm_b32 v58, v180, v176, s54
    v_accvgpr_write_b32 a46, v58
    v_perm_b32 v59, v188, v184, s54
    v_accvgpr_write_b32 a47, v59
    v_perm_b32 v56, v164, v160, s55
    v_accvgpr_write_b32 a60, v56
    v_perm_b32 v57, v172, v168, s55
    v_accvgpr_write_b32 a61, v57
    v_perm_b32 v58, v180, v176, s55
    v_accvgpr_write_b32 a62, v58
    v_perm_b32 v59, v188, v184, s55
    v_accvgpr_write_b32 a63, v59
    v_perm_b32 v56, v165, v161, s54
    v_accvgpr_write_b32 a76, v56
    v_perm_b32 v57, v173, v169, s54
    v_accvgpr_write_b32 a77, v57
    v_perm_b32 v58, v181, v177, s54
    v_accvgpr_write_b32 a78, v58
    v_perm_b32 v59, v189, v185, s54
    v_accvgpr_write_b32 a79, v59
    v_perm_b32 v56, v165, v161, s55
    v_accvgpr_write_b32 a92, v56
    v_perm_b32 v57, v173, v169, s55
    v_accvgpr_write_b32 a93, v57
    v_perm_b32 v58, v181, v177, s55
    v_accvgpr_write_b32 a94, v58
    v_perm_b32 v59, v189, v185, s55
    v_accvgpr_write_b32 a95, v59
    v_perm_b32 v56, v166, v162, s54
    v_accvgpr_write_b32 a108, v56
    v_perm_b32 v57, v174, v170, s54
    v_accvgpr_write_b32 a109, v57
    v_perm_b32 v58, v182, v178, s54
    v_accvgpr_write_b32 a110, v58
    v_perm_b32 v59, v190, v186, s54
    v_accvgpr_write_b32 a111, v59
    v_perm_b32 v56, v166, v162, s55
    v_accvgpr_write_b32 a124, v56
    v_perm_b32 v57, v174, v170, s55
    v_accvgpr_write_b32 a125, v57
    v_perm_b32 v58, v182, v178, s55
    v_accvgpr_write_b32 a126, v58
    v_perm_b32 v59, v190, v186, s55
    v_accvgpr_write_b32 a127, v59
    v_perm_b32 v56, v167, v163, s54
    v_accvgpr_write_b32 a140, v56
    v_perm_b32 v57, v175, v171, s54
    v_accvgpr_write_b32 a141, v57
    v_perm_b32 v58, v183, v179, s54
    v_accvgpr_write_b32 a142, v58
    v_perm_b32 v59, v191, v187, s54
    v_accvgpr_write_b32 a143, v59
    v_perm_b32 v56, v167, v163, s55
    v_accvgpr_write_b32 a156, v56
    v_perm_b32 v57, v175, v171, s55
    v_accvgpr_write_b32 a157, v57
    v_perm_b32 v58, v183, v179, s55
    v_accvgpr_write_b32 a158, v58
    v_perm_b32 v59, v191, v187, s55
    v_accvgpr_write_b32 a159, v59
    s_branch L_tail
L_w2:
    s_and_b32 s44, s2, 7
    s_lshl_b32 s44, s44, 5
    s_lshr_b32 s45, s2, 3
    s_add_u32 s44, s44, s45
    s_mov_b32 s36, s10
    s_mov_b32 s37, s11
    s_mov_b32 s38, 3670016
    s_mov_b32 s39, 0x20000
    v_lshrrev_b32 v8, 1, v0
    v_lshlrev_b32 v8, 13, v8
    v_and_b32 v9, 1, v0
    v_lshl_add_u32 v8, v9, 4, v8
    s_lshl_b32 s46, s44, 5
    s_lshr_b32 s48, s2, 5
    s_mul_i32 s48, s48, 5
    s_and_b32 s49, s2, 7
    s_mul_i32 s49, s49, 3
    s_add_u32 s48, s48, s49
    s_mul_hi_u32 s49, s48, 0x12492493
    s_mul_i32 s49, s49, 14
    s_sub_u32 s48, s48, s49
    s_cmp_ge_u32 s48, 14
    s_cselect_b32 s48, 0, s48
    s_lshl_b32 s47, s48, 18
    s_lshl_b32 s49, s48, 10
    s_add_u32 s47, s47, s46
    s_add_u32 m0, s49, 147456
    s_add_u32 s48, s48, 1
    buffer_load_dwordx4 v8, s[36:39], s47 offen nt lds
    s_cmp_eq_u32 s48, 14
    s_cselect_b32 s48, 0, s48
    s_lshl_b32 s47, s48, 18
    s_lshl_b32 s49, s48, 10
    s_add_u32 s47, s47, s46
    s_add_u32 m0, s49, 147456
    s_add_u32 s48, s48, 1
    buffer_load_dwordx4 v8, s[36:39], s47 offen nt lds
    s_cmp_eq_u32 s48, 14
    s_cselect_b32 s48, 0, s48
    s_lshl_b32 s47, s48, 18
    s_lshl_b32 s49, s48, 10
    s_add_u32 s47, s47, s46
    s_add_u32 m0, s49, 147456
    s_add_u32 s48, s48, 1
    buffer_load_dwordx4 v8, s[36:39], s47 offen nt lds
    s_cmp_eq_u32 s48, 14
    s_cselect_b32 s48, 0, s48
    s_lshl_b32 s47, s48, 18
    s_lshl_b32 s49, s48, 10
    s_add_u32 s47, s47, s46
    s_add_u32 m0, s49, 147456
    s_add_u32 s48, s48, 1
    buffer_load_dwordx4 v8, s[36:39], s47 offen nt lds
    s_cmp_eq_u32 s48, 14
    s_cselect_b32 s48, 0, s48
    s_lshl_b32 s47, s48, 18
    s_lshl_b32 s49, s48, 10
    s_add_u32 s47, s47, s46
    s_add_u32 m0, s49, 147456
    s_add_u32 s48, s48, 1
    buffer_load_dwordx4 v8, s[36:39], s47 offen nt lds
    s_cmp_eq_u32 s48, 14
    s_cselect_b32 s48, 0, s48
    s_lshl_b32 s47, s48, 18
    s_lshl_b32 s49, s48, 10
    s_add_u32 s47, s47, s46
    s_add_u32 m0, s49, 147456
    s_add_u32 s48, s48, 1
    buffer_load_dwordx4 v8, s[36:39], s47 offen nt lds
    s_cmp_eq_u32 s48, 14
    s_cselect_b32 s48, 0, s48
    s_lshl_b32 s47, s48, 18
    s_lshl_b32 s49, s48, 10
    s_add_u32 s47, s47, s46
    s_add_u32 m0, s49, 147456
    s_add_u32 s48, s48, 1
    buffer_load_dwordx4 v8, s[36:39], s47 offen nt lds
    s_cmp_eq_u32 s48, 14
    s_cselect_b32 s48, 0, s48
    s_lshl_b32 s47, s48, 18
    s_lshl_b32 s49, s48, 10
    s_add_u32 s47, s47, s46
    s_add_u32 m0, s49, 147456
    s_add_u32 s48, s48, 1
    buffer_load_dwordx4 v8, s[36:39], s47 offen nt lds
    s_cmp_eq_u32 s48, 14
    s_cselect_b32 s48, 0, s48
    s_lshl_b32 s47, s48, 18
    s_lshl_b32 s49, s48, 10
    s_add_u32 s47, s47, s46
    s_add_u32 m0, s49, 147456
    s_add_u32 s48, s48, 1
    buffer_load_dwordx4 v8, s[36:39], s47 offen nt lds
    s_cmp_eq_u32 s48, 14
    s_cselect_b32 s48, 0, s48
    s_lshl_b32 s47, s48, 18
    s_lshl_b32 s49, s48, 10
    s_add_u32 s47, s47, s46
    s_add_u32 m0, s49, 147456
    s_add_u32 s48, s48, 1
    buffer_load_dwordx4 v8, s[36:39], s47 offen nt lds
    s_cmp_eq_u32 s48, 14
    s_cselect_b32 s48, 0, s48
    s_lshl_b32 s47, s48, 18
    s_lshl_b32 s49, s48, 10
    s_add_u32 s47, s47, s46
    s_add_u32 m0, s49, 147456
    s_add_u32 s48, s48, 1
    buffer_load_dwordx4 v8, s[36:39], s47 offen nt lds
    s_cmp_eq_u32 s48, 14
    s_cselect_b32 s48, 0, s48
    s_lshl_b32 s47, s48, 18
    s_lshl_b32 s49, s48, 10
    s_add_u32 s47, s47, s46
    s_add_u32 m0, s49, 147456
    s_add_u32 s48, s48, 1
    buffer_load_dwordx4 v8, s[36:39], s47 offen nt lds
    s_cmp_eq_u32 s48, 14
    s_cselect_b32 s48, 0, s48
    s_lshl_b32 s47, s48, 18
    s_lshl_b32 s49, s48, 10
    s_add_u32 s47, s47, s46
    s_add_u32 m0, s49, 147456
    s_add_u32 s48, s48, 1
    buffer_load_dwordx4 v8, s[36:39], s47 offen nt lds
    s_cmp_eq_u32 s48, 14
    s_cselect_b32 s48, 0, s48
    s_lshl_b32 s47, s48, 18
    s_lshl_b32 s49, s48, 10
    s_add_u32 s47, s47, s46
    s_add_u32 m0, s49, 147456
    s_add_u32 s48, s48, 1
    buffer_load_dwordx4 v8, s[36:39], s47 offen nt lds
    s_cmp_eq_u32 s48, 14
    s_cselect_b32 s48, 0, s48
    s_barrier
    v_lshrrev_b32 v13, 4, v0
    v_lshlrev_b32 v13, 8, v13
    v_bfe_u32 v14, v0, 2, 2
    v_lshl_add_u32 v13, v14, 5, v13
    v_and_b32 v14, 3, v0
    v_lshl_add_u32 v13, v14, 3, v13
    v_add_u32 v13, 147456, v13
    v_and_b32 v10, 15, v0
    v_mul_u32_u24 v10, 928, v10
    v_lshrrev_b32 v11, 4, v0
    v_lshl_add_u32 v10, v11, 4, v10
    v_add_u32 v10, 49152, v10
    v_bfe_u32 v14, v0, 2, 2
    v_lshlrev_b32 v14, 13, v14
    v_and_b32 v15, 3, v0
    v_lshl_add_u32 v14, v15, 6, v14
    v_lshl_add_u32 v14, v11, 4, v14
    s_lshr_b32 s46, s44, 5
    s_lshl_b32 s46, s46, 16
    s_and_b32 s47, s44, 31
    s_lshl_b32 s47, s47, 8
    s_add_u32 s46, s46, s47
    s_add_u32 s47, s46, 32768
    s_waitcnt vmcnt(0)
    v_mov_b32 v62, 161792
    s_mov_b32 s52, 262144
L_wc_7:
    ds_read_b32 v63, v62 offset:48
    s_sub_u32 s52, s52, 1
    s_cbranch_scc1 L_wcx_8
    s_waitcnt lgkmcnt(0)
    v_readfirstlane_b32 s50, v63
    s_cmp_ge_u32 s50, 2
    s_cbranch_scc1 L_wcx_8
    s_branch L_wc_7
L_wcx_8:
    s_waitcnt lgkmcnt(0)
    s_waitcnt lgkmcnt(0)
    s_add_u32 s85, s84, 0x9e3779b9
    v_mov_b32 v30, s85
    s_nop 0
    v_readfirstlane_b32 s64, v30
    s_mov_b32 s66, 0xfffff000
    s_and_b32 s65, s64, 0xfff
    ds_read_b64_tr_b16 v[192:193], v13 offset:0
    ds_read_b64_tr_b16 v[194:195], v13 offset:128
    ds_read_b128 v[64:67], v10 offset:0
    ds_read_b128 v[120:123], v10 offset:14848
    ds_read_b64_tr_b16 v[196:197], v13 offset:1024
    ds_read_b64_tr_b16 v[198:199], v13 offset:1152
    ds_read_b128 v[68:71], v10 offset:64
    ds_read_b128 v[124:127], v10 offset:14912
    ds_read_b64_tr_b16 v[200:201], v13 offset:2048
    ds_read_b64_tr_b16 v[202:203], v13 offset:2176
    ds_read_b128 v[72:75], v10 offset:128
    ds_read_b128 v[128:131], v10 offset:14976
    ds_read_b64_tr_b16 v[204:205], v13 offset:3072
    ds_read_b64_tr_b16 v[206:207], v13 offset:3200
    ds_read_b128 v[76:79], v10 offset:192
    ds_read_b128 v[132:135], v10 offset:15040
    ds_read_b64_tr_b16 v[208:209], v13 offset:4096
    ds_read_b64_tr_b16 v[210:211], v13 offset:4224
    ds_read_b128 v[80:83], v10 offset:256
    ds_read_b128 v[136:139], v10 offset:15104
    ds_read_b64_tr_b16 v[212:213], v13 offset:5120
    ds_read_b64_tr_b16 v[214:215], v13 offset:5248
    ds_read_b128 v[84:87], v10 offset:320
    ds_read_b128 v[140:143], v10 offset:15168
    ds_read_b64_tr_b16 v[216:217], v13 offset:6144
    ds_read_b64_tr_b16 v[218:219], v13 offset:6272
    ds_read_b128 v[88:91], v10 offset:384
    ds_read_b128 v[144:147], v10 offset:15232
    ds_read_b64_tr_b16 v[220:221], v13 offset:7168
    ds_read_b64_tr_b16 v[222:223], v13 offset:7296
    ds_read_b128 v[92:95], v10 offset:448
    ds_read_b128 v[148:151], v10 offset:15296
    ds_read_b64_tr_b16 v[224:225], v13 offset:8192
    ds_read_b64_tr_b16 v[226:227], v13 offset:8320
    ds_read_b128 v[96:99], v10 offset:512
    ds_read_b128 v[152:155], v10 offset:15360
    ds_read_b64_tr_b16 v[228:229], v13 offset:9216
    ds_read_b64_tr_b16 v[230:231], v13 offset:9344
    ds_read_b128 v[100:103], v10 offset:576
    ds_read_b128 v[156:159], v10 offset:15424
    ds_read_b64_tr_b16 v[232:233], v13 offset:10240
    ds_read_b64_tr_b16 v[234:235], v13 offset:10368
    ds_read_b128 v[104:107], v10 offset:640
    ds_read_b128 v[160:163], v10 offset:15488
    ds_read_b64_tr_b16 v[236:237], v13 offset:11264
    ds_read_b64_tr_b16 v[238:239], v13 offset:11392
    ds_read_b128 v[108:111], v10 offset:704
    ds_read_b128 v[164:167], v10 offset:15552
    ds_read_b64_tr_b16 v[240:241], v13 offset:12288
    ds_read_b64_tr_b16 v[242:243], v13 offset:12416
    ds_read_b128 v[112:115], v10 offset:768
    ds_read_b128 v[168:171], v10 offset:15616
    ds_read_b64_tr_b16 v[244:245], v13 offset:13312
    ds_read_b64_tr_b16 v[246:247], v13 offset:13440
    ds_read_b128 v[116:119], v10 offset:832
    ds_read_b128 v[172:175], v10 offset:15680
    v_mov_b32 v25, v30
    v_mov_b32 v27, v30
    v_mov_b32 v33, v30
    v_mov_b32 v35, v30
    s_waitcnt lgkmcnt(0)
    v_mfma_f32_16x16x32_bf16 v[16:19], v[192:195], v[64:67], 0
    v_mfma_f32_16x16x32_bf16 v[20:23], v[192:195], v[120:123], 0
    v_mfma_f32_16x16x32_bf16 v[16:19], v[196:199], v[68:71], v[16:19]
    v_mfma_f32_16x16x32_bf16 v[20:23], v[196:199], v[124:127], v[20:23]
    v_mfma_f32_16x16x32_bf16 v[16:19], v[200:203], v[72:75], v[16:19]
    v_mfma_f32_16x16x32_bf16 v[20:23], v[200:203], v[128:131], v[20:23]
    v_mfma_f32_16x16x32_bf16 v[16:19], v[204:207], v[76:79], v[16:19]
    v_mfma_f32_16x16x32_bf16 v[20:23], v[204:207], v[132:135], v[20:23]
    v_mfma_f32_16x16x32_bf16 v[16:19], v[208:211], v[80:83], v[16:19]
    v_mfma_f32_16x16x32_bf16 v[20:23], v[208:211], v[136:139], v[20:23]
    v_mfma_f32_16x16x32_bf16 v[16:19], v[212:215], v[84:87], v[16:19]
    v_mfma_f32_16x16x32_bf16 v[20:23], v[212:215], v[140:143], v[20:23]
    v_mfma_f32_16x16x32_bf16 v[16:19], v[216:219], v[88:91], v[16:19]
    v_mfma_f32_16x16x32_bf16 v[20:23], v[216:219], v[144:147], v[20:23]
    v_mfma_f32_16x16x32_bf16 v[16:19], v[220:223], v[92:95], v[16:19]
    v_mfma_f32_16x16x32_bf16 v[20:23], v[220:223], v[148:151], v[20:23]
    v_mfma_f32_16x16x32_bf16 v[16:19], v[224:227], v[96:99], v[16:19]
    v_mfma_f32_16x16x32_bf16 v[20:23], v[224:227], v[152:155], v[20:23]
    v_mfma_f32_16x16x32_bf16 v[16:19], v[228:231], v[100:103], v[16:19]
    v_mfma_f32_16x16x32_bf16 v[20:23], v[228:231], v[156:159], v[20:23]
    v_mfma_f32_16x16x32_bf16 v[16:19], v[232:235], v[104:107], v[16:19]
    v_mfma_f32_16x16x32_bf16 v[20:23], v[232:235], v[160:163], v[20:23]
    v_mfma_f32_16x16x32_bf16 v[16:19], v[236:239], v[108:111], v[16:19]
    v_mfma_f32_16x16x32_bf16 v[20:23], v[236:239], v[164:167], v[20:23]
    v_mfma_f32_16x16x32_bf16 v[16:19], v[240:243], v[112:115], v[16:19]
    v_mfma_f32_16x16x32_bf16 v[20:23], v[240:243], v[168:171], v[20:23]
    v_mfma_f32_16x16x32_bf16 v[16:19], v[244:247], v[116:119], v[16:19]
    v_mfma_f32_16x16x32_bf16 v[20:23], v[244:247], v[172:175], v[20:23]
    v_mov_b32 v62, 161792
    v_mov_b32 v63, 1
    s_mov_b64 exec, 1
    ds_write_b32 v62, v63 offset:32
    s_mov_b64 exec, -1
    s_nop 3
    v_cvt_pk_bf16_f32 v24, v16, v17
    v_cvt_pk_bf16_f32 v26, v18, v19
    v_cvt_pk_bf16_f32 v32, v20, v21
    v_cvt_pk_bf16_f32 v34, v22, v23
    buffer_store_dwordx4 v[24:27], v14, s[28:31], s46 offen sc1
    buffer_store_dwordx4 v[32:35], v14, s[28:31], s47 offen sc1
    v_mov_b32 v62, 161792
    s_mov_b32 s52, 262144
L_wc_9:
    ds_read_b32 v63, v62 offset:96
    s_sub_u32 s52, s52, 1
    s_cbranch_scc1 L_wcx_10
    s_waitcnt lgkmcnt(0)
    v_readfirstlane_b32 s50, v63
    s_cmp_ge_u32 s50, 1
    s_cbranch_scc1 L_wcx_10
    s_sleep 8
    s_branch L_wc_9
L_wcx_10:
    s_waitcnt lgkmcnt(0)
    s_mov_b32 s32, s12
    s_mov_b32 s33, s13
    s_mov_b32 s34, 3670016
    s_mov_b32 s35, 0x20000
    s_lshl_b32 s56, s43, 2
    s_add_u32 s56, s56, s41
    s_mul_i32 s56, s56, 114688
    s_mul_i32 s53, s3, 224
    s_add_u32 s56, s56, s53
    v_lshrrev_b32 v60, 4, v0
    v_mul_u32_u24 v60, 3584, v60
    v_and_b32 v61, 15, v0
    v_lshl_add_u32 v60, v61, 4, v60
    s_mov_b32 s54, 0x05040100
    s_mov_b32 s55, 0x07060302
    s_add_u32 s53, s56, 0
    buffer_load_dwordx4 v[64:67], v60, s[32:35], s53 offen
    s_add_u32 s53, s56, 896
    buffer_load_dwordx4 v[68:71], v60, s[32:35], s53 offen
    s_add_u32 s53, s56, 1792
    buffer_load_dwordx4 v[72:75], v60, s[32:35], s53 offen
    s_add_u32 s53, s56, 2688
    buffer_load_dwordx4 v[76:79], v60, s[32:35], s53 offen
    s_add_u32 s53, s56, 14336
    buffer_load_dwordx4 v[80:83], v60, s[32:35], s53 offen
    s_add_u32 s53, s56, 15232
    buffer_load_dwordx4 v[84:87], v60, s[32:35], s53 offen
    s_add_u32 s53, s56, 16128
    buffer_load_dwordx4 v[88:91], v60, s[32:35], s53 offen
    s_add_u32 s53, s56, 17024
    buffer_load_dwordx4 v[92:95], v60, s[32:35], s53 offen
    s_add_u32 s53, s56, 28672
    buffer_load_dwordx4 v[96:99], v60, s[32:35], s53 offen
    s_add_u32 s53, s56, 29568
    buffer_load_dwordx4 v[100:103], v60, s[32:35], s53 offen
    s_add_u32 s53, s56, 30464
    buffer_load_dwordx4 v[104:107], v60, s[32:35], s53 offen
    s_add_u32 s53, s56, 31360
    buffer_load_dwordx4 v[108:111], v60, s[32:35], s53 offen
    s_add_u32 s53, s56, 43008
    buffer_load_dwordx4 v[112:115], v60, s[32:35], s53 offen
    s_add_u32 s53, s56, 43904
    buffer_load_dwordx4 v[116:119], v60, s[32:35], s53 offen
    s_add_u32 s53, s56, 44800
    buffer_load_dwordx4 v[120:123], v60, s[32:35], s53 offen
    s_add_u32 s53, s56, 45696
    buffer_load_dwordx4 v[124:127], v60, s[32:35], s53 offen
    s_add_u32 s53, s56, 57344
    buffer_load_dwordx4 v[128:131], v60, s[32:35], s53 offen
    s_add_u32 s53, s56, 58240
    buffer_load_dwordx4 v[132:135], v60, s[32:35], s53 offen
    s_add_u32 s53, s56, 59136
    buffer_load_dwordx4 v[136:139], v60, s[32:35], s53 offen
    s_add_u32 s53, s56, 60032
    buffer_load_dwordx4 v[140:143], v60, s[32:35], s53 offen
    s_add_u32 s53, s56, 71680
    buffer_load_dwordx4 v[144:147], v60, s[32:35], s53 offen
    s_add_u32 s53, s56, 72576
    buffer_load_dwordx4 v[148:151], v60, s[32:35], s53 offen
    s_add_u32 s53, s56, 73472
    buffer_load_dwordx4 v[152:155], v60, s[32:35], s53 offen
    s_add_u32 s53, s56, 74368
    buffer_load_dwordx4 v[156:159], v60, s[32:35], s53 offen
    s_add_u32 s53, s56, 86016
    buffer_load_dwordx4 v[160:163], v60, s[32:35], s53 offen
    s_add_u32 s53, s56, 86912
    buffer_load_dwordx4 v[164:167], v60, s[32:35], s53 offen
    s_add_u32 s53, s56, 87808
    buffer_load_dwordx4 v[168:171], v60, s[32:35], s53 offen
    s_add_u32 s53, s56, 88704
    buffer_load_dwordx4 v[172:175], v60, s[32:35], s53 offen
    s_add_u32 s53, s56, 100352
    buffer_load_dwordx4 v[176:179], v60, s[32:35], s53 offen
    s_add_u32 s53, s56, 101248
    buffer_load_dwordx4 v[180:183], v60, s[32:35], s53 offen
    s_add_u32 s53, s56, 102144
    buffer_load_dwordx4 v[184:187], v60, s[32:35], s53 offen
    s_add_u32 s53, s56, 103040
    buffer_load_dwordx4 v[188:191], v60, s[32:35], s53 offen
    s_waitcnt vmcnt(24)
    v_perm_b32 v56, v68, v64, s54
    v_accvgpr_write_b32 a32, v56
    v_perm_b32 v57, v76, v72, s54
    v_accvgpr_write_b32 a33, v57
    v_perm_b32 v58, v84, v80, s54
    v_accvgpr_write_b32 a34, v58
    v_perm_b32 v59, v92, v88, s54
    v_accvgpr_write_b32 a35, v59
    v_perm_b32 v56, v68, v64, s55
    v_accvgpr_write_b32 a48, v56
    v_perm_b32 v57, v76, v72, s55
    v_accvgpr_write_b32 a49, v57
    v_perm_b32 v58, v84, v80, s55
    v_accvgpr_write_b32 a50, v58
    v_perm_b32 v59, v92, v88, s55
    v_accvgpr_write_b32 a51, v59
    v_perm_b32 v56, v69, v65, s54
    v_accvgpr_write_b32 a64, v56
    v_perm_b32 v57, v77, v73, s54
    v_accvgpr_write_b32 a65, v57
    v_perm_b32 v58, v85, v81, s54
    v_accvgpr_write_b32 a66, v58
    v_perm_b32 v59, v93, v89, s54
    v_accvgpr_write_b32 a67, v59
    v_perm_b32 v56, v69, v65, s55
    v_accvgpr_write_b32 a80, v56
    v_perm_b32 v57, v77, v73, s55
    v_accvgpr_write_b32 a81, v57
    v_perm_b32 v58, v85, v81, s55
    v_accvgpr_write_b32 a82, v58
    v_perm_b32 v59, v93, v89, s55
    v_accvgpr_write_b32 a83, v59
    v_perm_b32 v56, v70, v66, s54
    v_accvgpr_write_b32 a96, v56
    v_perm_b32 v57, v78, v74, s54
    v_accvgpr_write_b32 a97, v57
    v_perm_b32 v58, v86, v82, s54
    v_accvgpr_write_b32 a98, v58
    v_perm_b32 v59, v94, v90, s54
    v_accvgpr_write_b32 a99, v59
    v_perm_b32 v56, v70, v66, s55
    v_accvgpr_write_b32 a112, v56
    v_perm_b32 v57, v78, v74, s55
    v_accvgpr_write_b32 a113, v57
    v_perm_b32 v58, v86, v82, s55
    v_accvgpr_write_b32 a114, v58
    v_perm_b32 v59, v94, v90, s55
    v_accvgpr_write_b32 a115, v59
    v_perm_b32 v56, v71, v67, s54
    v_accvgpr_write_b32 a128, v56
    v_perm_b32 v57, v79, v75, s54
    v_accvgpr_write_b32 a129, v57
    v_perm_b32 v58, v87, v83, s54
    v_accvgpr_write_b32 a130, v58
    v_perm_b32 v59, v95, v91, s54
    v_accvgpr_write_b32 a131, v59
    v_perm_b32 v56, v71, v67, s55
    v_accvgpr_write_b32 a144, v56
    v_perm_b32 v57, v79, v75, s55
    v_accvgpr_write_b32 a145, v57
    v_perm_b32 v58, v87, v83, s55
    v_accvgpr_write_b32 a146, v58
    v_perm_b32 v59, v95, v91, s55
    v_accvgpr_write_b32 a147, v59
    s_waitcnt vmcnt(16)
    v_perm_b32 v56, v100, v96, s54
    v_accvgpr_write_b32 a36, v56
    v_perm_b32 v57, v108, v104, s54
    v_accvgpr_write_b32 a37, v57
    v_perm_b32 v58, v116, v112, s54
    v_accvgpr_write_b32 a38, v58
    v_perm_b32 v59, v124, v120, s54
    v_accvgpr_write_b32 a39, v59
    v_perm_b32 v56, v100, v96, s55
    v_accvgpr_write_b32 a52, v56
    v_perm_b32 v57, v108, v104, s55
    v_accvgpr_write_b32 a53, v57
    v_perm_b32 v58, v116, v112, s55
    v_accvgpr_write_b32 a54, v58
    v_perm_b32 v59, v124, v120, s55
    v_accvgpr_write_b32 a55, v59
    v_perm_b32 v56, v101, v97, s54
    v_accvgpr_write_b32 a68, v56
    v_perm_b32 v57, v109, v105, s54
    v_accvgpr_write_b32 a69, v57
    v_perm_b32 v58, v117, v113, s54
    v_accvgpr_write_b32 a70, v58
    v_perm_b32 v59, v125, v121, s54
    v_accvgpr_write_b32 a71, v59
    v_perm_b32 v56, v101, v97, s55
    v_accvgpr_write_b32 a84, v56
    v_perm_b32 v57, v109, v105, s55
    v_accvgpr_write_b32 a85, v57
    v_perm_b32 v58, v117, v113, s55
    v_accvgpr_write_b32 a86, v58
    v_perm_b32 v59, v125, v121, s55
    v_accvgpr_write_b32 a87, v59
    v_perm_b32 v56, v102, v98, s54
    v_accvgpr_write_b32 a100, v56
    v_perm_b32 v57, v110, v106, s54
    v_accvgpr_write_b32 a101, v57
    v_perm_b32 v58, v118, v114, s54
    v_accvgpr_write_b32 a102, v58
    v_perm_b32 v59, v126, v122, s54
    v_accvgpr_write_b32 a103, v59
    v_perm_b32 v56, v102, v98, s55
    v_accvgpr_write_b32 a116, v56
    v_perm_b32 v57, v110, v106, s55
    v_accvgpr_write_b32 a117, v57
    v_perm_b32 v58, v118, v114, s55
    v_accvgpr_write_b32 a118, v58
    v_perm_b32 v59, v126, v122, s55
    v_accvgpr_write_b32 a119, v59
    v_perm_b32 v56, v103, v99, s54
    v_accvgpr_write_b32 a132, v56
    v_perm_b32 v57, v111, v107, s54
    v_accvgpr_write_b32 a133, v57
    v_perm_b32 v58, v119, v115, s54
    v_accvgpr_write_b32 a134, v58
    v_perm_b32 v59, v127, v123, s54
    v_accvgpr_write_b32 a135, v59
    v_perm_b32 v56, v103, v99, s55
    v_accvgpr_write_b32 a148, v56
    v_perm_b32 v57, v111, v107, s55
    v_accvgpr_write_b32 a149, v57
    v_perm_b32 v58, v119, v115, s55
    v_accvgpr_write_b32 a150, v58
    v_perm_b32 v59, v127, v123, s55
    v_accvgpr_write_b32 a151, v59
    s_waitcnt vmcnt(8)
    v_perm_b32 v56, v132, v128, s54
    v_accvgpr_write_b32 a40, v56
    v_perm_b32 v57, v140, v136, s54
    v_accvgpr_write_b32 a41, v57
    v_perm_b32 v58, v148, v144, s54
    v_accvgpr_write_b32 a42, v58
    v_perm_b32 v59, v156, v152, s54
    v_accvgpr_write_b32 a43, v59
    v_perm_b32 v56, v132, v128, s55
    v_accvgpr_write_b32 a56, v56
    v_perm_b32 v57, v140, v136, s55
    v_accvgpr_write_b32 a57, v57
    v_perm_b32 v58, v148, v144, s55
    v_accvgpr_write_b32 a58, v58
    v_perm_b32 v59, v156, v152, s55
    v_accvgpr_write_b32 a59, v59
    v_perm_b32 v56, v133, v129, s54
    v_accvgpr_write_b32 a72, v56
    v_perm_b32 v57, v141, v137, s54
    v_accvgpr_write_b32 a73, v57
    v_perm_b32 v58, v149, v145, s54
    v_accvgpr_write_b32 a74, v58
    v_perm_b32 v59, v157, v153, s54
    v_accvgpr_write_b32 a75, v59
    v_perm_b32 v56, v133, v129, s55
    v_accvgpr_write_b32 a88, v56
    v_perm_b32 v57, v141, v137, s55
    v_accvgpr_write_b32 a89, v57
    v_perm_b32 v58, v149, v145, s55
    v_accvgpr_write_b32 a90, v58
    v_perm_b32 v59, v157, v153, s55
    v_accvgpr_write_b32 a91, v59
    v_perm_b32 v56, v134, v130, s54
    v_accvgpr_write_b32 a104, v56
    v_perm_b32 v57, v142, v138, s54
    v_accvgpr_write_b32 a105, v57
    v_perm_b32 v58, v150, v146, s54
    v_accvgpr_write_b32 a106, v58
    v_perm_b32 v59, v158, v154, s54
    v_accvgpr_write_b32 a107, v59
    v_perm_b32 v56, v134, v130, s55
    v_accvgpr_write_b32 a120, v56
    v_perm_b32 v57, v142, v138, s55
    v_accvgpr_write_b32 a121, v57
    v_perm_b32 v58, v150, v146, s55
    v_accvgpr_write_b32 a122, v58
    v_perm_b32 v59, v158, v154, s55
    v_accvgpr_write_b32 a123, v59
    v_perm_b32 v56, v135, v131, s54
    v_accvgpr_write_b32 a136, v56
    v_perm_b32 v57, v143, v139, s54
    v_accvgpr_write_b32 a137, v57
    v_perm_b32 v58, v151, v147, s54
    v_accvgpr_write_b32 a138, v58
    v_perm_b32 v59, v159, v155, s54
    v_accvgpr_write_b32 a139, v59
    v_perm_b32 v56, v135, v131, s55
    v_accvgpr_write_b32 a152, v56
    v_perm_b32 v57, v143, v139, s55
    v_accvgpr_write_b32 a153, v57
    v_perm_b32 v58, v151, v147, s55
    v_accvgpr_write_b32 a154, v58
    v_perm_b32 v59, v159, v155, s55
    v_accvgpr_write_b32 a155, v59
    s_waitcnt vmcnt(0)
    v_perm_b32 v56, v164, v160, s54
    v_accvgpr_write_b32 a44, v56
    v_perm_b32 v57, v172, v168, s54
    v_accvgpr_write_b32 a45, v57
    v_perm_b32 v58, v180, v176, s54
    v_accvgpr_write_b32 a46, v58
    v_perm_b32 v59, v188, v184, s54
    v_accvgpr_write_b32 a47, v59
    v_perm_b32 v56, v164, v160, s55
    v_accvgpr_write_b32 a60, v56
    v_perm_b32 v57, v172, v168, s55
    v_accvgpr_write_b32 a61, v57
    v_perm_b32 v58, v180, v176, s55
    v_accvgpr_write_b32 a62, v58
    v_perm_b32 v59, v188, v184, s55
    v_accvgpr_write_b32 a63, v59
    v_perm_b32 v56, v165, v161, s54
    v_accvgpr_write_b32 a76, v56
    v_perm_b32 v57, v173, v169, s54
    v_accvgpr_write_b32 a77, v57
    v_perm_b32 v58, v181, v177, s54
    v_accvgpr_write_b32 a78, v58
    v_perm_b32 v59, v189, v185, s54
    v_accvgpr_write_b32 a79, v59
    v_perm_b32 v56, v165, v161, s55
    v_accvgpr_write_b32 a92, v56
    v_perm_b32 v57, v173, v169, s55
    v_accvgpr_write_b32 a93, v57
    v_perm_b32 v58, v181, v177, s55
    v_accvgpr_write_b32 a94, v58
    v_perm_b32 v59, v189, v185, s55
    v_accvgpr_write_b32 a95, v59
    v_perm_b32 v56, v166, v162, s54
    v_accvgpr_write_b32 a108, v56
    v_perm_b32 v57, v174, v170, s54
    v_accvgpr_write_b32 a109, v57
    v_perm_b32 v58, v182, v178, s54
    v_accvgpr_write_b32 a110, v58
    v_perm_b32 v59, v190, v186, s54
    v_accvgpr_write_b32 a111, v59
    v_perm_b32 v56, v166, v162, s55
    v_accvgpr_write_b32 a124, v56
    v_perm_b32 v57, v174, v170, s55
    v_accvgpr_write_b32 a125, v57
    v_perm_b32 v58, v182, v178, s55
    v_accvgpr_write_b32 a126, v58
    v_perm_b32 v59, v190, v186, s55
    v_accvgpr_write_b32 a127, v59
    v_perm_b32 v56, v167, v163, s54
    v_accvgpr_write_b32 a140, v56
    v_perm_b32 v57, v175, v171, s54
    v_accvgpr_write_b32 a141, v57
    v_perm_b32 v58, v183, v179, s54
    v_accvgpr_write_b32 a142, v58
    v_perm_b32 v59, v191, v187, s54
    v_accvgpr_write_b32 a143, v59
    v_perm_b32 v56, v167, v163, s55
    v_accvgpr_write_b32 a156, v56
    v_perm_b32 v57, v175, v171, s55
    v_accvgpr_write_b32 a157, v57
    v_perm_b32 v58, v183, v179, s55
    v_accvgpr_write_b32 a158, v58
    v_perm_b32 v59, v191, v187, s55
    v_accvgpr_write_b32 a159, v59
    s_branch L_tail
L_w3:
    s_mov_b32 s32, s4
    s_mov_b32 s33, s5
    s_mov_b32 s34, 28672
    s_mov_b32 s35, 0x20000
    v_lshlrev_b32 v2, 4, v0
    s_mov_b32 exec_hi, 0x00ffffff
    s_mov_b32 s47, 0
    s_mov_b32 m0, 49152
    s_nop 0
    buffer_load_dwordx4 v2, s[32:35], s47 offen lds
    s_mov_b32 m0, 50080
    s_add_u32 s47, s47, 896
    buffer_load_dwordx4 v2, s[32:35], s47 offen lds
    s_mov_b32 m0, 51008
    s_add_u32 s47, s47, 896
    buffer_load_dwordx4 v2, s[32:35], s47 offen lds
    s_mov_b32 m0, 51936
    s_add_u32 s47, s47, 896
    buffer_load_dwordx4 v2, s[32:35], s47 offen lds
    s_mov_b32 m0, 52864
    s_add_u32 s47, s47, 896
    buffer_load_dwordx4 v2, s[32:35], s47 offen lds
    s_mov_b32 m0, 53792
    s_add_u32 s47, s47, 896
    buffer_load_dwordx4 v2, s[32:35], s47 offen lds
    s_mov_b32 m0, 54720
    s_add_u32 s47, s47, 896
    buffer_load_dwordx4 v2, s[32:35], s47 offen lds
    s_mov_b32 m0, 55648
    s_add_u32 s47, s47, 896
    buffer_load_dwordx4 v2, s[32:35], s47 offen lds
    s_mov_b32 m0, 56576
    s_add_u32 s47, s47, 896
    buffer_load_dwordx4 v2, s[32:35], s47 offen lds
    s_mov_b32 m0, 57504
    s_add_u32 s47, s47, 896
    buffer_load_dwordx4 v2, s[32:35], s47 offen lds
    s_mov_b32 m0, 58432
    s_add_u32 s47, s47, 896
    buffer_load_dwordx4 v2, s[32:35], s47 offen lds
    s_mov_b32 m0, 59360
    s_add_u32 s47, s47, 896
    buffer_load_dwordx4 v2, s[32:35], s47 offen lds
    s_mov_b32 m0, 60288
    s_add_u32 s47, s47, 896
    buffer_load_dwordx4 v2, s[32:35], s47 offen lds
    s_mov_b32 m0, 61216
    s_add_u32 s47, s47, 896
    buffer_load_dwordx4 v2, s[32:35], s47 offen lds
    s_mov_b32 m0, 62144
    s_add_u32 s47, s47, 896
    buffer_load_dwordx4 v2, s[32:35], s47 offen lds
    s_mov_b32 m0, 63072
    s_add_u32 s47, s47, 896
    buffer_load_dwordx4 v2, s[32:35], s47 offen lds
    s_mov_b32 exec_hi, -1
    s_barrier
    v_mov_b32 v62, 161792
    v_mov_b32 v63, 1
    s_waitcnt vmcnt(0)
    s_mov_b64 exec, 1
    ds_add_u32 v62, v63 offset:48
    s_mov_b64 exec, -1
    s_waitcnt lgkmcnt(0)
    s_add_u32 s85, s84, 0x9e3779b9
    v_mov_b32 v30, s85
    s_nop 0
    v_readfirstlane_b32 s64, v30
    s_mov_b32 s66, 0xfffff000
    s_and_b32 s65, s64, 0xfff
    s_cmp_lg_u32 s41, 0
    s_cbranch_scc1 L_noti_11
    v_and_b32 v31, 0xffffff00, v30
    s_lshl_b32 s44, s40, 7
    s_add_u32 s44, s44, 589824
    v_mov_b32 v29, 0
    s_mov_b64 exec, 1
    buffer_store_dword v31, v29, s[28:31], s44 offen sc1
    s_mov_b64 exec, -1
L_noti_11:
    v_mov_b32 v62, 161792
    s_mov_b32 s52, 262144
L_wc_12:
    ds_read_b32 v63, v62 offset:32
    s_sub_u32 s52, s52, 1
    s_cbranch_scc1 L_wcx_13
    s_waitcnt lgkmcnt(0)
    v_readfirstlane_b32 s50, v63
    s_cmp_ge_u32 s50, 1
    s_cbranch_scc1 L_wcx_13
    s_sleep 8
    s_branch L_wc_12
L_wcx_13:
    s_waitcnt lgkmcnt(0)
    v_mov_b32 v62, 161792
    s_mov_b32 s52, 262144
L_wc_14:
    ds_read_b32 v63, v62 offset:64
    s_sub_u32 s52, s52, 1
    s_cbranch_scc1 L_wcx_15
    s_waitcnt lgkmcnt(0)
    v_readfirstlane_b32 s50, v63
    s_cmp_ge_u32 s50, 1
    s_cbranch_scc1 L_wcx_15
    s_sleep 8
    s_branch L_wc_14
L_wcx_15:
    s_waitcnt lgkmcnt(0)
    s_mov_b32 s36, s16
    s_mov_b32 s37, s17
    s_mov_b32 s38, 256
    s_mov_b32 s39, 0x20000
    s_and_b32 s46, s2, 63
    s_lshl_b32 s46, s46, 2
    v_mov_b32 v14, 0
    v_mov_b32 v15, 1
    s_mov_b64 exec, 1
    buffer_atomic_add v15, v14, s[36:39], s46 offen
    s_mov_b64 exec, -1
    s_cmp_lg_u32 s2, 0
    s_cbranch_scc1 L_noep_16
    v_mov_b32 v62, 161792
    s_mov_b32 s52, 262144
L_wc_17:
    ds_read_b32 v63, v62 offset:64
    s_sub_u32 s52, s52, 1
    s_cbranch_scc1 L_wcx_18
    s_waitcnt lgkmcnt(0)
    v_readfirstlane_b32 s50, v63
    s_cmp_ge_u32 s50, 16
    s_cbranch_scc1 L_wcx_18
    s_sleep 8
    s_branch L_wc_17
L_wcx_18:
    s_waitcnt lgkmcnt(0)
    s_mov_b32 s36, s16
    s_mov_b32 s37, s17
    s_mov_b32 s38, 256
    s_mov_b32 s39, 0x20000
    v_lshlrev_b32 v1, 2, v0
    s_mov_b32 s49, 262144
L_qpoll_19:
    buffer_load_dword v2, v1, s[36:39], 0 offen sc1
    s_waitcnt vmcnt(0)
    v_bfe_u32 v2, v2, 0, 8
    v_cmp_gt_u32 vcc, 4, v2
    s_nop 1
    s_cmp_eq_u64 vcc, 0
    s_cbranch_scc1 L_qdone_20
    s_sleep 4
    s_sub_u32 s49, s49, 1
    s_cmp_lg_u32 s49, 0
    s_cbranch_scc1 L_qpoll_19
L_qdone_20:
    v_mov_b32 v30, s64
    v_mov_b32 v31, 524288
    s_mov_b64 exec, 1
    buffer_store_dword v30, v31, s[28:31], 0 offen sc1
    s_mov_b64 exec, -1
L_noep_16:
    v_mov_b32 v62, 161792
    s_mov_b32 s52, 262144
L_wc_21:
    ds_read_b32 v63, v62 offset:96
    s_sub_u32 s52, s52, 1
    s_cbranch_scc1 L_wcx_22
    s_waitcnt lgkmcnt(0)
    v_readfirstlane_b32 s50, v63
    s_cmp_ge_u32 s50, 1
    s_cbranch_scc1 L_wcx_22
    s_sleep 8
    s_branch L_wc_21
L_wcx_22:
    s_waitcnt lgkmcnt(0)
    s_mov_b32 s32, s12
    s_mov_b32 s33, s13
    s_mov_b32 s34, 3670016
    s_mov_b32 s35, 0x20000
    s_lshl_b32 s56, s43, 2
    s_add_u32 s56, s56, s41
    s_mul_i32 s56, s56, 114688
    s_mul_i32 s53, s3, 224
    s_add_u32 s56, s56, s53
    v_lshrrev_b32 v60, 4, v0
    v_mul_u32_u24 v60, 3584, v60
    v_and_b32 v61, 15, v0
    v_lshl_add_u32 v60, v61, 4, v60
    s_mov_b32 s54, 0x05040100
    s_mov_b32 s55, 0x07060302
    s_add_u32 s53, s56, 0
    buffer_load_dwordx4 v[64:67], v60, s[32:35], s53 offen
    s_add_u32 s53, s56, 896
    buffer_load_dwordx4 v[68:71], v60, s[32:35], s53 offen
    s_add_u32 s53, s56, 1792
    buffer_load_dwordx4 v[72:75], v60, s[32:35], s53 offen
    s_add_u32 s53, s56, 2688
    buffer_load_dwordx4 v[76:79], v60, s[32:35], s53 offen
    s_add_u32 s53, s56, 14336
    buffer_load_dwordx4 v[80:83], v60, s[32:35], s53 offen
    s_add_u32 s53, s56, 15232
    buffer_load_dwordx4 v[84:87], v60, s[32:35], s53 offen
    s_add_u32 s53, s56, 16128
    buffer_load_dwordx4 v[88:91], v60, s[32:35], s53 offen
    s_add_u32 s53, s56, 17024
    buffer_load_dwordx4 v[92:95], v60, s[32:35], s53 offen
    s_add_u32 s53, s56, 28672
    buffer_load_dwordx4 v[96:99], v60, s[32:35], s53 offen
    s_add_u32 s53, s56, 29568
    buffer_load_dwordx4 v[100:103], v60, s[32:35], s53 offen
    s_add_u32 s53, s56, 30464
    buffer_load_dwordx4 v[104:107], v60, s[32:35], s53 offen
    s_add_u32 s53, s56, 31360
    buffer_load_dwordx4 v[108:111], v60, s[32:35], s53 offen
    s_add_u32 s53, s56, 43008
    buffer_load_dwordx4 v[112:115], v60, s[32:35], s53 offen
    s_add_u32 s53, s56, 43904
    buffer_load_dwordx4 v[116:119], v60, s[32:35], s53 offen
    s_add_u32 s53, s56, 44800
    buffer_load_dwordx4 v[120:123], v60, s[32:35], s53 offen
    s_add_u32 s53, s56, 45696
    buffer_load_dwordx4 v[124:127], v60, s[32:35], s53 offen
    s_add_u32 s53, s56, 57344
    buffer_load_dwordx4 v[128:131], v60, s[32:35], s53 offen
    s_add_u32 s53, s56, 58240
    buffer_load_dwordx4 v[132:135], v60, s[32:35], s53 offen
    s_add_u32 s53, s56, 59136
    buffer_load_dwordx4 v[136:139], v60, s[32:35], s53 offen
    s_add_u32 s53, s56, 60032
    buffer_load_dwordx4 v[140:143], v60, s[32:35], s53 offen
    s_add_u32 s53, s56, 71680
    buffer_load_dwordx4 v[144:147], v60, s[32:35], s53 offen
    s_add_u32 s53, s56, 72576
    buffer_load_dwordx4 v[148:151], v60, s[32:35], s53 offen
    s_add_u32 s53, s56, 73472
    buffer_load_dwordx4 v[152:155], v60, s[32:35], s53 offen
    s_add_u32 s53, s56, 74368
    buffer_load_dwordx4 v[156:159], v60, s[32:35], s53 offen
    s_add_u32 s53, s56, 86016
    buffer_load_dwordx4 v[160:163], v60, s[32:35], s53 offen
    s_add_u32 s53, s56, 86912
    buffer_load_dwordx4 v[164:167], v60, s[32:35], s53 offen
    s_add_u32 s53, s56, 87808
    buffer_load_dwordx4 v[168:171], v60, s[32:35], s53 offen
    s_add_u32 s53, s56, 88704
    buffer_load_dwordx4 v[172:175], v60, s[32:35], s53 offen
    s_add_u32 s53, s56, 100352
    buffer_load_dwordx4 v[176:179], v60, s[32:35], s53 offen
    s_add_u32 s53, s56, 101248
    buffer_load_dwordx4 v[180:183], v60, s[32:35], s53 offen
    s_add_u32 s53, s56, 102144
    buffer_load_dwordx4 v[184:187], v60, s[32:35], s53 offen
    s_add_u32 s53, s56, 103040
    buffer_load_dwordx4 v[188:191], v60, s[32:35], s53 offen
    s_waitcnt vmcnt(24)
    v_perm_b32 v56, v68, v64, s54
    v_accvgpr_write_b32 a32, v56
    v_perm_b32 v57, v76, v72, s54
    v_accvgpr_write_b32 a33, v57
    v_perm_b32 v58, v84, v80, s54
    v_accvgpr_write_b32 a34, v58
    v_perm_b32 v59, v92, v88, s54
    v_accvgpr_write_b32 a35, v59
    v_perm_b32 v56, v68, v64, s55
    v_accvgpr_write_b32 a48, v56
    v_perm_b32 v57, v76, v72, s55
    v_accvgpr_write_b32 a49, v57
    v_perm_b32 v58, v84, v80, s55
    v_accvgpr_write_b32 a50, v58
    v_perm_b32 v59, v92, v88, s55
    v_accvgpr_write_b32 a51, v59
    v_perm_b32 v56, v69, v65, s54
    v_accvgpr_write_b32 a64, v56
    v_perm_b32 v57, v77, v73, s54
    v_accvgpr_write_b32 a65, v57
    v_perm_b32 v58, v85, v81, s54
    v_accvgpr_write_b32 a66, v58
    v_perm_b32 v59, v93, v89, s54
    v_accvgpr_write_b32 a67, v59
    v_perm_b32 v56, v69, v65, s55
    v_accvgpr_write_b32 a80, v56
    v_perm_b32 v57, v77, v73, s55
    v_accvgpr_write_b32 a81, v57
    v_perm_b32 v58, v85, v81, s55
    v_accvgpr_write_b32 a82, v58
    v_perm_b32 v59, v93, v89, s55
    v_accvgpr_write_b32 a83, v59
    v_perm_b32 v56, v70, v66, s54
    v_accvgpr_write_b32 a96, v56
    v_perm_b32 v57, v78, v74, s54
    v_accvgpr_write_b32 a97, v57
    v_perm_b32 v58, v86, v82, s54
    v_accvgpr_write_b32 a98, v58
    v_perm_b32 v59, v94, v90, s54
    v_accvgpr_write_b32 a99, v59
    v_perm_b32 v56, v70, v66, s55
    v_accvgpr_write_b32 a112, v56
    v_perm_b32 v57, v78, v74, s55
    v_accvgpr_write_b32 a113, v57
    v_perm_b32 v58, v86, v82, s55
    v_accvgpr_write_b32 a114, v58
    v_perm_b32 v59, v94, v90, s55
    v_accvgpr_write_b32 a115, v59
    v_perm_b32 v56, v71, v67, s54
    v_accvgpr_write_b32 a128, v56
    v_perm_b32 v57, v79, v75, s54
    v_accvgpr_write_b32 a129, v57
    v_perm_b32 v58, v87, v83, s54
    v_accvgpr_write_b32 a130, v58
    v_perm_b32 v59, v95, v91, s54
    v_accvgpr_write_b32 a131, v59
    v_perm_b32 v56, v71, v67, s55
    v_accvgpr_write_b32 a144, v56
    v_perm_b32 v57, v79, v75, s55
    v_accvgpr_write_b32 a145, v57
    v_perm_b32 v58, v87, v83, s55
    v_accvgpr_write_b32 a146, v58
    v_perm_b32 v59, v95, v91, s55
    v_accvgpr_write_b32 a147, v59
    s_waitcnt vmcnt(16)
    v_perm_b32 v56, v100, v96, s54
    v_accvgpr_write_b32 a36, v56
    v_perm_b32 v57, v108, v104, s54
    v_accvgpr_write_b32 a37, v57
    v_perm_b32 v58, v116, v112, s54
    v_accvgpr_write_b32 a38, v58
    v_perm_b32 v59, v124, v120, s54
    v_accvgpr_write_b32 a39, v59
    v_perm_b32 v56, v100, v96, s55
    v_accvgpr_write_b32 a52, v56
    v_perm_b32 v57, v108, v104, s55
    v_accvgpr_write_b32 a53, v57
    v_perm_b32 v58, v116, v112, s55
    v_accvgpr_write_b32 a54, v58
    v_perm_b32 v59, v124, v120, s55
    v_accvgpr_write_b32 a55, v59
    v_perm_b32 v56, v101, v97, s54
    v_accvgpr_write_b32 a68, v56
    v_perm_b32 v57, v109, v105, s54
    v_accvgpr_write_b32 a69, v57
    v_perm_b32 v58, v117, v113, s54
    v_accvgpr_write_b32 a70, v58
    v_perm_b32 v59, v125, v121, s54
    v_accvgpr_write_b32 a71, v59
    v_perm_b32 v56, v101, v97, s55
    v_accvgpr_write_b32 a84, v56
    v_perm_b32 v57, v109, v105, s55
    v_accvgpr_write_b32 a85, v57
    v_perm_b32 v58, v117, v113, s55
    v_accvgpr_write_b32 a86, v58
    v_perm_b32 v59, v125, v121, s55
    v_accvgpr_write_b32 a87, v59
    v_perm_b32 v56, v102, v98, s54
    v_accvgpr_write_b32 a100, v56
    v_perm_b32 v57, v110, v106, s54
    v_accvgpr_write_b32 a101, v57
    v_perm_b32 v58, v118, v114, s54
    v_accvgpr_write_b32 a102, v58
    v_perm_b32 v59, v126, v122, s54
    v_accvgpr_write_b32 a103, v59
    v_perm_b32 v56, v102, v98, s55
    v_accvgpr_write_b32 a116, v56
    v_perm_b32 v57, v110, v106, s55
    v_accvgpr_write_b32 a117, v57
    v_perm_b32 v58, v118, v114, s55
    v_accvgpr_write_b32 a118, v58
    v_perm_b32 v59, v126, v122, s55
    v_accvgpr_write_b32 a119, v59
    v_perm_b32 v56, v103, v99, s54
    v_accvgpr_write_b32 a132, v56
    v_perm_b32 v57, v111, v107, s54
    v_accvgpr_write_b32 a133, v57
    v_perm_b32 v58, v119, v115, s54
    v_accvgpr_write_b32 a134, v58
    v_perm_b32 v59, v127, v123, s54
    v_accvgpr_write_b32 a135, v59
    v_perm_b32 v56, v103, v99, s55
    v_accvgpr_write_b32 a148, v56
    v_perm_b32 v57, v111, v107, s55
    v_accvgpr_write_b32 a149, v57
    v_perm_b32 v58, v119, v115, s55
    v_accvgpr_write_b32 a150, v58
    v_perm_b32 v59, v127, v123, s55
    v_accvgpr_write_b32 a151, v59
    s_waitcnt vmcnt(8)
    v_perm_b32 v56, v132, v128, s54
    v_accvgpr_write_b32 a40, v56
    v_perm_b32 v57, v140, v136, s54
    v_accvgpr_write_b32 a41, v57
    v_perm_b32 v58, v148, v144, s54
    v_accvgpr_write_b32 a42, v58
    v_perm_b32 v59, v156, v152, s54
    v_accvgpr_write_b32 a43, v59
    v_perm_b32 v56, v132, v128, s55
    v_accvgpr_write_b32 a56, v56
    v_perm_b32 v57, v140, v136, s55
    v_accvgpr_write_b32 a57, v57
    v_perm_b32 v58, v148, v144, s55
    v_accvgpr_write_b32 a58, v58
    v_perm_b32 v59, v156, v152, s55
    v_accvgpr_write_b32 a59, v59
    v_perm_b32 v56, v133, v129, s54
    v_accvgpr_write_b32 a72, v56
    v_perm_b32 v57, v141, v137, s54
    v_accvgpr_write_b32 a73, v57
    v_perm_b32 v58, v149, v145, s54
    v_accvgpr_write_b32 a74, v58
    v_perm_b32 v59, v157, v153, s54
    v_accvgpr_write_b32 a75, v59
    v_perm_b32 v56, v133, v129, s55
    v_accvgpr_write_b32 a88, v56
    v_perm_b32 v57, v141, v137, s55
    v_accvgpr_write_b32 a89, v57
    v_perm_b32 v58, v149, v145, s55
    v_accvgpr_write_b32 a90, v58
    v_perm_b32 v59, v157, v153, s55
    v_accvgpr_write_b32 a91, v59
    v_perm_b32 v56, v134, v130, s54
    v_accvgpr_write_b32 a104, v56
    v_perm_b32 v57, v142, v138, s54
    v_accvgpr_write_b32 a105, v57
    v_perm_b32 v58, v150, v146, s54
    v_accvgpr_write_b32 a106, v58
    v_perm_b32 v59, v158, v154, s54
    v_accvgpr_write_b32 a107, v59
    v_perm_b32 v56, v134, v130, s55
    v_accvgpr_write_b32 a120, v56
    v_perm_b32 v57, v142, v138, s55
    v_accvgpr_write_b32 a121, v57
    v_perm_b32 v58, v150, v146, s55
    v_accvgpr_write_b32 a122, v58
    v_perm_b32 v59, v158, v154, s55
    v_accvgpr_write_b32 a123, v59
    v_perm_b32 v56, v135, v131, s54
    v_accvgpr_write_b32 a136, v56
    v_perm_b32 v57, v143, v139, s54
    v_accvgpr_write_b32 a137, v57
    v_perm_b32 v58, v151, v147, s54
    v_accvgpr_write_b32 a138, v58
    v_perm_b32 v59, v159, v155, s54
    v_accvgpr_write_b32 a139, v59
    v_perm_b32 v56, v135, v131, s55
    v_accvgpr_write_b32 a152, v56
    v_perm_b32 v57, v143, v139, s55
    v_accvgpr_write_b32 a153, v57
    v_perm_b32 v58, v151, v147, s55
    v_accvgpr_write_b32 a154, v58
    v_perm_b32 v59, v159, v155, s55
    v_accvgpr_write_b32 a155, v59
    s_waitcnt vmcnt(0)
    v_perm_b32 v56, v164, v160, s54
    v_accvgpr_write_b32 a44, v56
    v_perm_b32 v57, v172, v168, s54
    v_accvgpr_write_b32 a45, v57
    v_perm_b32 v58, v180, v176, s54
    v_accvgpr_write_b32 a46, v58
    v_perm_b32 v59, v188, v184, s54
    v_accvgpr_write_b32 a47, v59
    v_perm_b32 v56, v164, v160, s55
    v_accvgpr_write_b32 a60, v56
    v_perm_b32 v57, v172, v168, s55
    v_accvgpr_write_b32 a61, v57
    v_perm_b32 v58, v180, v176, s55
    v_accvgpr_write_b32 a62, v58
    v_perm_b32 v59, v188, v184, s55
    v_accvgpr_write_b32 a63, v59
    v_perm_b32 v56, v165, v161, s54
    v_accvgpr_write_b32 a76, v56
    v_perm_b32 v57, v173, v169, s54
    v_accvgpr_write_b32 a77, v57
    v_perm_b32 v58, v181, v177, s54
    v_accvgpr_write_b32 a78, v58
    v_perm_b32 v59, v189, v185, s54
    v_accvgpr_write_b32 a79, v59
    v_perm_b32 v56, v165, v161, s55
    v_accvgpr_write_b32 a92, v56
    v_perm_b32 v57, v173, v169, s55
    v_accvgpr_write_b32 a93, v57
    v_perm_b32 v58, v181, v177, s55
    v_accvgpr_write_b32 a94, v58
    v_perm_b32 v59, v189, v185, s55
    v_accvgpr_write_b32 a95, v59
    v_perm_b32 v56, v166, v162, s54
    v_accvgpr_write_b32 a108, v56
    v_perm_b32 v57, v174, v170, s54
    v_accvgpr_write_b32 a109, v57
    v_perm_b32 v58, v182, v178, s54
    v_accvgpr_write_b32 a110, v58
    v_perm_b32 v59, v190, v186, s54
    v_accvgpr_write_b32 a111, v59
    v_perm_b32 v56, v166, v162, s55
    v_accvgpr_write_b32 a124, v56
    v_perm_b32 v57, v174, v170, s55
    v_accvgpr_write_b32 a125, v57
    v_perm_b32 v58, v182, v178, s55
    v_accvgpr_write_b32 a126, v58
    v_perm_b32 v59, v190, v186, s55
    v_accvgpr_write_b32 a127, v59
    v_perm_b32 v56, v167, v163, s54
    v_accvgpr_write_b32 a140, v56
    v_perm_b32 v57, v175, v171, s54
    v_accvgpr_write_b32 a141, v57
    v_perm_b32 v58, v183, v179, s54
    v_accvgpr_write_b32 a142, v58
    v_perm_b32 v59, v191, v187, s54
    v_accvgpr_write_b32 a143, v59
    v_perm_b32 v56, v167, v163, s55
    v_accvgpr_write_b32 a156, v56
    v_perm_b32 v57, v175, v171, s55
    v_accvgpr_write_b32 a157, v57
    v_perm_b32 v58, v183, v179, s55
    v_accvgpr_write_b32 a158, v58
    v_perm_b32 v59, v191, v187, s55
    v_accvgpr_write_b32 a159, v59
    s_branch L_tail
L_w1:
    v_mov_b32 v28, 161792
    v_mov_b32 v29, 0
    ds_write_b32 v28, v29 offset:0
    ds_write_b32 v28, v29 offset:64
    ds_write_b32 v28, v29 offset:32
    ds_write_b32 v28, v29 offset:96
    ds_write_b32 v28, v29 offset:48
    ds_write_b32 v28, v29 offset:80
    ds_write_b32 v28, v29 offset:112
    ds_write_b32 v28, v29 offset:120
    ds_write_b32 v28, v29 offset:16
    ds_write_b32 v28, v29 offset:24
    ds_write_b32 v28, v29 offset:40
    v_mov_b32 v1, 0x7fffffff
    ds_write_b32 v28, v1 offset:4
    s_mov_b32 s32, s4
    s_mov_b32 s33, s5
    s_mov_b32 s34, 28672
    s_mov_b32 s35, 0x20000
    v_lshlrev_b32 v2, 4, v0
    s_mov_b32 exec_hi, 0x00ffffff
    s_mov_b32 s47, 14336
    s_mov_b32 m0, 64000
    s_nop 0
    buffer_load_dwordx4 v2, s[32:35], s47 offen lds
    s_mov_b32 m0, 64928
    s_add_u32 s47, s47, 896
    buffer_load_dwordx4 v2, s[32:35], s47 offen lds
    s_mov_b32 m0, 65856
    s_add_u32 s47, s47, 896
    buffer_load_dwordx4 v2, s[32:35], s47 offen lds
    s_mov_b32 m0, 66784
    s_add_u32 s47, s47, 896
    buffer_load_dwordx4 v2, s[32:35], s47 offen lds
    s_mov_b32 m0, 67712
    s_add_u32 s47, s47, 896
    buffer_load_dwordx4 v2, s[32:35], s47 offen lds
    s_mov_b32 m0, 68640
    s_add_u32 s47, s47, 896
    buffer_load_dwordx4 v2, s[32:35], s47 offen lds
    s_mov_b32 m0, 69568
    s_add_u32 s47, s47, 896
    buffer_load_dwordx4 v2, s[32:35], s47 offen lds
    s_mov_b32 m0, 70496
    s_add_u32 s47, s47, 896
    buffer_load_dwordx4 v2, s[32:35], s47 offen lds
    s_mov_b32 m0, 71424
    s_add_u32 s47, s47, 896
    buffer_load_dwordx4 v2, s[32:35], s47 offen lds
    s_mov_b32 m0, 72352
    s_add_u32 s47, s47, 896
    buffer_load_dwordx4 v2, s[32:35], s47 offen lds
    s_mov_b32 m0, 73280
    s_add_u32 s47, s47, 896
    buffer_load_dwordx4 v2, s[32:35], s47 offen lds
    s_mov_b32 m0, 74208
    s_add_u32 s47, s47, 896
    buffer_load_dwordx4 v2, s[32:35], s47 offen lds
    s_mov_b32 m0, 75136
    s_add_u32 s47, s47, 896
    buffer_load_dwordx4 v2, s[32:35], s47 offen lds
    s_mov_b32 m0, 76064
    s_add_u32 s47, s47, 896
    buffer_load_dwordx4 v2, s[32:35], s47 offen lds
    s_mov_b32 m0, 76992
    s_add_u32 s47, s47, 896
    buffer_load_dwordx4 v2, s[32:35], s47 offen lds
    s_mov_b32 m0, 77920
    s_add_u32 s47, s47, 896
    buffer_load_dwordx4 v2, s[32:35], s47 offen lds
    s_mov_b32 exec_hi, -1
    s_waitcnt lgkmcnt(0)
    s_barrier
    v_lshlrev_b32 v24, 4, v0
    v_lshrrev_b32 v1, 4, v0
    v_bfe_u32 v2, v0, 2, 2
    v_and_b32 v3, 3, v0
    v_and_b32 v4, 1, v1
    v_lshl_add_u32 v4, v4, 2, v2
    v_lshlrev_b32 v5, 11, v1
    v_lshl_add_u32 v5, v2, 8, v5
    v_lshl_add_u32 v5, v3, 3, v5
    v_xor_b32 v6, 0, v4
    v_lshl_add_u32 v8, v6, 5, v5
    v_xor_b32 v6, 1, v4
    v_lshl_add_u32 v9, v6, 5, v5
    v_xor_b32 v6, 2, v4
    v_lshl_add_u32 v10, v6, 5, v5
    v_xor_b32 v6, 3, v4
    v_lshl_add_u32 v11, v6, 5, v5
    v_xor_b32 v6, 4, v4
    v_lshl_add_u32 v12, v6, 5, v5
    v_xor_b32 v6, 5, v4
    v_lshl_add_u32 v13, v6, 5, v5
    v_xor_b32 v6, 6, v4
    v_lshl_add_u32 v14, v6, 5, v5
    v_xor_b32 v6, 7, v4
    v_lshl_add_u32 v15, v6, 5, v5
    v_mov_b32 v192, 0
    v_mov_b32 v193, 0
    v_mov_b32 v194, 0
    v_mov_b32 v195, 0
    v_mov_b32 v196, 0
    v_mov_b32 v197, 0
    v_mov_b32 v198, 0
    v_mov_b32 v199, 0
    v_mov_b32 v200, 0
    v_mov_b32 v201, 0
    v_mov_b32 v202, 0
    v_mov_b32 v203, 0
    v_mov_b32 v204, 0
    v_mov_b32 v205, 0
    v_mov_b32 v206, 0
    v_mov_b32 v207, 0
    v_mov_b32 v208, 0
    v_mov_b32 v209, 0
    v_mov_b32 v210, 0
    v_mov_b32 v211, 0
    v_mov_b32 v212, 0
    v_mov_b32 v213, 0
    v_mov_b32 v214, 0
    v_mov_b32 v215, 0
    v_mov_b32 v216, 0
    v_mov_b32 v217, 0
    v_mov_b32 v218, 0
    v_mov_b32 v219, 0
    v_mov_b32 v220, 0
    v_mov_b32 v221, 0
    v_mov_b32 v222, 0
    v_mov_b32 v223, 0
    v_mov_b32 v224, 0
    v_mov_b32 v225, 0
    v_mov_b32 v226, 0
    v_mov_b32 v227, 0
    v_mov_b32 v228, 0
    v_mov_b32 v229, 0
    v_mov_b32 v230, 0
    v_mov_b32 v231, 0
    v_mov_b32 v232, 0
    v_mov_b32 v233, 0
    v_mov_b32 v234, 0
    v_mov_b32 v235, 0
    v_mov_b32 v236, 0
    v_mov_b32 v237, 0
    v_mov_b32 v238, 0
    v_mov_b32 v239, 0
    v_mov_b32 v240, 0
    v_mov_b32 v241, 0
    v_mov_b32 v242, 0
    v_mov_b32 v243, 0
    v_mov_b32 v244, 0
    v_mov_b32 v245, 0
    v_mov_b32 v246, 0
    v_mov_b32 v247, 0
    v_mov_b32 v248, 0
    v_mov_b32 v249, 0
    v_mov_b32 v250, 0
    v_mov_b32 v251, 0
    v_mov_b32 v252, 0
    v_mov_b32 v253, 0
    v_mov_b32 v254, 0
    v_mov_b32 v255, 0
    v_mov_b32 v26, 0xff800000
    v_mov_b32 v27, 0
    s_mov_b32 s47, 0x3db8aa3b
    s_mov_b32 s48, 0x41000000
    v_mov_b32 v62, 161792
    v_mov_b32 v63, 1
    s_waitcnt vmcnt(0)
    s_mov_b64 exec, 1
    ds_add_u32 v62, v63 offset:48
    s_mov_b64 exec, -1
    v_bfe_u32 v1, v0, 2, 1
    v_lshlrev_b32 v1, 12, v1
    v_lshrrev_b32 v2, 5, v0
    v_lshl_add_u32 v1, v2, 8, v1
    v_and_b32 v2, 3, v0
    v_lshl_add_u32 v1, v2, 6, v1
    v_bfe_u32 v2, v0, 4, 1
    v_lshl_add_u32 v1, v2, 5, v1
    s_lshl_b32 s49, s43, 16
    s_lshl_b32 s50, s42, 13
    s_add_u32 s49, s49, s50
    s_mov_b32 s52, 262144
L_qs_23:
    ds_read_b32 v29, v28 offset:0
    s_sub_u32 s52, s52, 1
    s_cbranch_scc1 L_qsx_24
    s_waitcnt lgkmcnt(0)
    v_readfirstlane_b32 s50, v29
    s_cmp_ge_u32 s50, 2
    s_cbranch_scc0 L_qs_23
L_qsx_24:
    s_waitcnt vmcnt(0) lgkmcnt(0)
    s_waitcnt lgkmcnt(0)
    s_add_u32 s85, s84, 0x9e3779b9
    v_mov_b32 v54, s85
    s_nop 0
    v_readfirstlane_b32 s64, v54
    s_mov_b32 s66, 0xfffff000
    s_and_b32 s65, s64, 0xfff
    s_mov_b32 s59, 19
    v_lshlrev_b32 v3, 4, v0
    s_add_u32 s50, s49, 4096
    s_mov_b32 s51, 262144
L_qpoll_25:
    buffer_load_dwordx4 v[64:67], v3, s[28:31], s49 offen offset:0 sc1
    buffer_load_dwordx4 v[68:71], v3, s[28:31], s49 offen offset:1024 sc1
    buffer_load_dwordx4 v[72:75], v3, s[28:31], s49 offen offset:2048 sc1
    buffer_load_dwordx4 v[76:79], v3, s[28:31], s49 offen offset:3072 sc1
    buffer_load_dwordx4 v[80:83], v3, s[28:31], s50 offen offset:0 sc1
    buffer_load_dwordx4 v[84:87], v3, s[28:31], s50 offen offset:1024 sc1
    buffer_load_dwordx4 v[88:91], v3, s[28:31], s50 offen offset:2048 sc1
    buffer_load_dwordx4 v[92:95], v3, s[28:31], s50 offen offset:3072 sc1
    s_waitcnt vmcnt(0)
    v_mov_b32 v2, 0
    v_bitop3_b32 v2, v2, v65, v54 bitop3:0xf6
    v_bitop3_b32 v2, v2, v67, v54 bitop3:0xf6
    v_bitop3_b32 v2, v2, v69, v54 bitop3:0xf6
    v_bitop3_b32 v2, v2, v71, v54 bitop3:0xf6
    v_bitop3_b32 v2, v2, v73, v54 bitop3:0xf6
    v_bitop3_b32 v2, v2, v75, v54 bitop3:0xf6
    v_bitop3_b32 v2, v2, v77, v54 bitop3:0xf6
    v_bitop3_b32 v2, v2, v79, v54 bitop3:0xf6
    v_bitop3_b32 v2, v2, v81, v54 bitop3:0xf6
    v_bitop3_b32 v2, v2, v83, v54 bitop3:0xf6
    v_bitop3_b32 v2, v2, v85, v54 bitop3:0xf6
    v_bitop3_b32 v2, v2, v87, v54 bitop3:0xf6
    v_bitop3_b32 v2, v2, v89, v54 bitop3:0xf6
    v_bitop3_b32 v2, v2, v91, v54 bitop3:0xf6
    v_bitop3_b32 v2, v2, v93, v54 bitop3:0xf6
    v_bitop3_b32 v2, v2, v95, v54 bitop3:0xf6
    v_cmp_ne_u32 vcc, 0, v2
    s_nop 1
    s_cmp_eq_u64 vcc, 0
    s_cbranch_scc1 L_qdone_26
    s_sub_u32 s51, s51, 1
    s_cmp_lg_u32 s51, 0
    s_cbranch_scc1 L_qpoll_25
L_qdone_26:
    v_mov_b32 v62, 161792
    s_mov_b32 s52, 262144
L_wc_27:
    ds_read_b32 v63, v62 offset:32
    s_sub_u32 s52, s52, 1
    s_cbranch_scc1 L_wcx_28
    s_waitcnt lgkmcnt(0)
    v_readfirstlane_b32 s50, v63
    s_cmp_ge_u32 s50, 1
    s_cbranch_scc1 L_wcx_28
    s_branch L_wc_27
L_wcx_28:
    s_waitcnt lgkmcnt(0)
    v_add_u32 v3, 147456, v3
    ds_write_b128 v3, v[64:67] offset:0
    ds_write_b128 v3, v[68:71] offset:1024
    ds_write_b128 v3, v[72:75] offset:2048
    ds_write_b128 v3, v[76:79] offset:3072
    ds_write_b128 v3, v[80:83] offset:4096
    ds_write_b128 v3, v[84:87] offset:5120
    ds_write_b128 v3, v[88:91] offset:6144
    ds_write_b128 v3, v[92:95] offset:7168
    v_add_u32 v1, 147456, v1
    s_waitcnt lgkmcnt(0)
    ds_read_b128 v[64:67], v1 offset:0
    ds_read_b128 v[68:71], v1 offset:16
    ds_read_b128 v[72:75], v1 offset:512
    ds_read_b128 v[76:79], v1 offset:528
    ds_read_b128 v[80:83], v1 offset:1024
    ds_read_b128 v[84:87], v1 offset:1040
    ds_read_b128 v[88:91], v1 offset:1536
    ds_read_b128 v[92:95], v1 offset:1552
    ds_read_b128 v[96:99], v1 offset:2048
    ds_read_b128 v[100:103], v1 offset:2064
    ds_read_b128 v[104:107], v1 offset:2560
    ds_read_b128 v[108:111], v1 offset:2576
    ds_read_b128 v[112:115], v1 offset:3072
    ds_read_b128 v[116:119], v1 offset:3088
    ds_read_b128 v[120:123], v1 offset:3584
    ds_read_b128 v[124:127], v1 offset:3600
    s_waitcnt lgkmcnt(0)
    v_accvgpr_write_b32 a0, v64
    v_accvgpr_write_b32 a1, v66
    v_accvgpr_write_b32 a2, v68
    v_accvgpr_write_b32 a3, v70
    v_accvgpr_write_b32 a4, v72
    v_accvgpr_write_b32 a5, v74
    v_accvgpr_write_b32 a6, v76
    v_accvgpr_write_b32 a7, v78
    v_accvgpr_write_b32 a8, v80
    v_accvgpr_write_b32 a9, v82
    v_accvgpr_write_b32 a10, v84
    v_accvgpr_write_b32 a11, v86
    v_accvgpr_write_b32 a12, v88
    v_accvgpr_write_b32 a13, v90
    v_accvgpr_write_b32 a14, v92
    v_accvgpr_write_b32 a15, v94
    v_accvgpr_write_b32 a16, v96
    v_accvgpr_write_b32 a17, v98
    v_accvgpr_write_b32 a18, v100
    v_accvgpr_write_b32 a19, v102
    v_accvgpr_write_b32 a20, v104
    v_accvgpr_write_b32 a21, v106
    v_accvgpr_write_b32 a22, v108
    v_accvgpr_write_b32 a23, v110
    v_accvgpr_write_b32 a24, v112
    v_accvgpr_write_b32 a25, v114
    v_accvgpr_write_b32 a26, v116
    v_accvgpr_write_b32 a27, v118
    v_accvgpr_write_b32 a28, v120
    v_accvgpr_write_b32 a29, v122
    v_accvgpr_write_b32 a30, v124
    v_accvgpr_write_b32 a31, v126
    s_mov_b32 s44, 0
    s_mov_b32 s45, 81920
    s_mov_b32 s46, 49152
    s_mov_b32 s58, 0
    s_add_u32 s49, s44, 1
    s_mov_b32 s52, 262144
L_lpoll_29:
    ds_read_b64 v[62:63], v28 offset:0
    s_sub_u32 s52, s52, 1
    s_cbranch_scc1 L_lpollx_30
    s_waitcnt lgkmcnt(0)
    v_readfirstlane_b32 s50, v62
    s_cmp_ge_u32 s50, s49
    s_cbranch_scc1 L_lpollx_30
    s_sleep 1
    s_branch L_lpoll_29
L_lpollx_30:
    s_waitcnt lgkmcnt(0)
    v_add_u32 v25, s45, v24
    ds_read_b128 v[64:67], v25 offset:0
    ds_read_b128 v[68:71], v25 offset:1024
    ds_read_b128 v[72:75], v25 offset:2048
    ds_read_b128 v[76:79], v25 offset:3072
    ds_read_b128 v[80:83], v25 offset:4096
    ds_read_b128 v[84:87], v25 offset:5120
    ds_read_b128 v[88:91], v25 offset:6144
    ds_read_b128 v[92:95], v25 offset:7168
    ds_read_b128 v[96:99], v25 offset:8192
    ds_read_b128 v[100:103], v25 offset:9216
    ds_read_b128 v[104:107], v25 offset:10240
    ds_read_b128 v[108:111], v25 offset:11264
    ds_read_b128 v[112:115], v25 offset:12288
    ds_read_b128 v[116:119], v25 offset:13312
    ds_read_b128 v[120:123], v25 offset:14336
    ds_read_b128 v[124:127], v25 offset:15360
    s_waitcnt lgkmcnt(0)
    v_mfma_f32_16x16x32_bf16 v[32:35], v[64:67], a[0:3], 0
    v_mfma_f32_16x16x32_bf16 v[36:39], v[96:99], a[0:3], 0
    v_mfma_f32_16x16x32_bf16 v[32:35], v[68:71], a[4:7], v[32:35]
    v_mfma_f32_16x16x32_bf16 v[36:39], v[100:103], a[4:7], v[36:39]
    v_mfma_f32_16x16x32_bf16 v[32:35], v[72:75], a[8:11], v[32:35]
    v_mfma_f32_16x16x32_bf16 v[36:39], v[104:107], a[8:11], v[36:39]
    v_mfma_f32_16x16x32_bf16 v[32:35], v[76:79], a[12:15], v[32:35]
    v_mfma_f32_16x16x32_bf16 v[36:39], v[108:111], a[12:15], v[36:39]
    v_mfma_f32_16x16x32_bf16 v[32:35], v[80:83], a[16:19], v[32:35]
    v_mfma_f32_16x16x32_bf16 v[36:39], v[112:115], a[16:19], v[36:39]
    v_mfma_f32_16x16x32_bf16 v[32:35], v[84:87], a[20:23], v[32:35]
    v_mfma_f32_16x16x32_bf16 v[36:39], v[116:119], a[20:23], v[36:39]
    v_mfma_f32_16x16x32_bf16 v[32:35], v[88:91], a[24:27], v[32:35]
    v_mfma_f32_16x16x32_bf16 v[36:39], v[120:123], a[24:27], v[36:39]
    v_mfma_f32_16x16x32_bf16 v[32:35], v[92:95], a[28:31], v[32:35]
    v_mfma_f32_16x16x32_bf16 v[36:39], v[124:127], a[28:31], v[36:39]
    s_waitcnt lgkmcnt(0)
    s_add_u32 s49, s44, 1
    v_mov_b32 v29, s49
    s_mov_b64 exec, 1
    ds_write_b32 v28, v29 offset:64
    s_mov_b64 exec, -1
    s_nop 7
    v_max3_f32 v52, v32, v33, v34
    v_max3_f32 v52, v52, v35, v36
    v_max3_f32 v52, v52, v37, v38
    v_max_f32 v52, v52, v39
    v_fma_f32 v53, v52, s47, -v26
    v_cmp_lt_f32 vcc, s48, v53
    s_nop 1
    s_cmp_lg_u64 vcc, 0
    s_cbranch_scc1 L_rare_31
L_back_32:
    v_fma_f32 v40, v32, s47, -v26
    v_fma_f32 v41, v33, s47, -v26
    v_fma_f32 v42, v34, s47, -v26
    v_fma_f32 v43, v35, s47, -v26
    v_fma_f32 v44, v36, s47, -v26
    v_fma_f32 v45, v37, s47, -v26
    v_fma_f32 v46, v38, s47, -v26
    v_fma_f32 v47, v39, s47, -v26
    v_exp_f32 v40, v40
    v_exp_f32 v41, v41
    v_exp_f32 v42, v42
    v_exp_f32 v43, v43
    v_exp_f32 v44, v44
    v_exp_f32 v45, v45
    v_exp_f32 v46, v46
    v_exp_f32 v47, v47
    s_nop 0
    v_cvt_pk_bf16_f32 v48, v40, v41
    v_cvt_pk_bf16_f32 v49, v42, v43
    v_cvt_pk_bf16_f32 v50, v44, v45
    v_cvt_pk_bf16_f32 v51, v46, v47
    v_add_f32 v40, v40, v41
    v_add_f32 v42, v42, v43
    v_add_f32 v44, v44, v45
    v_add_f32 v46, v46, v47
    v_add_f32 v40, v40, v42
    v_add_f32 v44, v44, v46
    v_add_f32 v27, v27, v40
    v_add_f32 v27, v27, v44
    s_add_u32 s44, s44, 1
    s_add_u32 s45, s45, 16384
    s_cmp_eq_u32 s45, 147456
    s_cselect_b32 s45, 65536, s45
    s_add_u32 s46, s46, 16384
    s_cmp_eq_u32 s46, 65536
    s_cselect_b32 s46, 0, s46
L_c_loop:
    s_add_u32 s49, s44, 1
    s_mov_b32 s52, 262144
L_lpoll_33:
    ds_read_b64 v[62:63], v28 offset:0
    s_sub_u32 s52, s52, 1
    s_cbranch_scc1 L_lpollx_34
    s_waitcnt lgkmcnt(0)
    v_readfirstlane_b32 s50, v62
    v_readfirstlane_b32 s51, v63
    s_cmp_eq_u32 s51, s44
    s_cbranch_scc1 L_c_last
    s_cmp_ge_u32 s50, s49
    s_cbranch_scc1 L_lpollx_34
    s_sleep 1
    s_branch L_lpoll_33
L_lpollx_34:
    s_waitcnt lgkmcnt(0)
    v_add_u32 v25, s45, v24
    v_add_u32 v16, s46, v8
    v_add_u32 v17, s46, v9
    v_add_u32 v18, s46, v10
    v_add_u32 v19, s46, v11
    v_add_u32 v20, s46, v12
    v_add_u32 v21, s46, v13
    v_add_u32 v22, s46, v14
    v_add_u32 v23, s46, v15
    ds_read_b128 v[64:67], v25 offset:0
    ds_read_b128 v[68:71], v25 offset:1024
    ds_read_b128 v[72:75], v25 offset:2048
    ds_read_b128 v[76:79], v25 offset:3072
    ds_read_b128 v[80:83], v25 offset:4096
    ds_read_b128 v[84:87], v25 offset:5120
    ds_read_b128 v[88:91], v25 offset:6144
    ds_read_b128 v[92:95], v25 offset:7168
    ds_read_b128 v[96:99], v25 offset:8192
    ds_read_b128 v[100:103], v25 offset:9216
    ds_read_b128 v[104:107], v25 offset:10240
    ds_read_b128 v[108:111], v25 offset:11264
    ds_read_b128 v[112:115], v25 offset:12288
    ds_read_b128 v[116:119], v25 offset:13312
    ds_read_b128 v[120:123], v25 offset:14336
    ds_read_b128 v[124:127], v25 offset:15360
    s_waitcnt lgkmcnt(0)
    v_mfma_f32_16x16x32_bf16 v[32:35], v[64:67], a[0:3], 0
    ds_read_b64_tr_b16 v[128:129], v16 offset:0
    ds_read_b64_tr_b16 v[130:131], v16 offset:8192
    v_mfma_f32_16x16x32_bf16 v[36:39], v[96:99], a[0:3], 0
    ds_read_b64_tr_b16 v[132:133], v17 offset:0
    ds_read_b64_tr_b16 v[134:135], v17 offset:8192
    v_mfma_f32_16x16x32_bf16 v[32:35], v[68:71], a[4:7], v[32:35]
    ds_read_b64_tr_b16 v[136:137], v18 offset:0
    ds_read_b64_tr_b16 v[138:139], v18 offset:8192
    v_mfma_f32_16x16x32_bf16 v[36:39], v[100:103], a[4:7], v[36:39]
    ds_read_b64_tr_b16 v[140:141], v19 offset:0
    ds_read_b64_tr_b16 v[142:143], v19 offset:8192
    v_mfma_f32_16x16x32_bf16 v[32:35], v[72:75], a[8:11], v[32:35]
    ds_read_b64_tr_b16 v[144:145], v20 offset:0
    ds_read_b64_tr_b16 v[146:147], v20 offset:8192
    v_mfma_f32_16x16x32_bf16 v[36:39], v[104:107], a[8:11], v[36:39]
    ds_read_b64_tr_b16 v[148:149], v21 offset:0
    ds_read_b64_tr_b16 v[150:151], v21 offset:8192
    v_mfma_f32_16x16x32_bf16 v[32:35], v[76:79], a[12:15], v[32:35]
    ds_read_b64_tr_b16 v[152:153], v22 offset:0
    ds_read_b64_tr_b16 v[154:155], v22 offset:8192
    v_mfma_f32_16x16x32_bf16 v[36:39], v[108:111], a[12:15], v[36:39]
    ds_read_b64_tr_b16 v[156:157], v23 offset:0
    ds_read_b64_tr_b16 v[158:159], v23 offset:8192
    v_mfma_f32_16x16x32_bf16 v[32:35], v[80:83], a[16:19], v[32:35]
    ds_read_b64_tr_b16 v[160:161], v16 offset:1024
    ds_read_b64_tr_b16 v[162:163], v16 offset:9216
    v_mfma_f32_16x16x32_bf16 v[36:39], v[112:115], a[16:19], v[36:39]
    ds_read_b64_tr_b16 v[164:165], v17 offset:1024
    ds_read_b64_tr_b16 v[166:167], v17 offset:9216
    v_mfma_f32_16x16x32_bf16 v[32:35], v[84:87], a[20:23], v[32:35]
    ds_read_b64_tr_b16 v[168:169], v18 offset:1024
    ds_read_b64_tr_b16 v[170:171], v18 offset:9216
    v_mfma_f32_16x16x32_bf16 v[36:39], v[116:119], a[20:23], v[36:39]
    ds_read_b64_tr_b16 v[172:173], v19 offset:1024
    ds_read_b64_tr_b16 v[174:175], v19 offset:9216
    v_mfma_f32_16x16x32_bf16 v[32:35], v[88:91], a[24:27], v[32:35]
    ds_read_b64_tr_b16 v[176:177], v20 offset:1024
    ds_read_b64_tr_b16 v[178:179], v20 offset:9216
    v_mfma_f32_16x16x32_bf16 v[36:39], v[120:123], a[24:27], v[36:39]
    ds_read_b64_tr_b16 v[180:181], v21 offset:1024
    ds_read_b64_tr_b16 v[182:183], v21 offset:9216
    v_mfma_f32_16x16x32_bf16 v[32:35], v[92:95], a[28:31], v[32:35]
    ds_read_b64_tr_b16 v[184:185], v22 offset:1024
    ds_read_b64_tr_b16 v[186:187], v22 offset:9216
    v_mfma_f32_16x16x32_bf16 v[36:39], v[124:127], a[28:31], v[36:39]
    ds_read_b64_tr_b16 v[188:189], v23 offset:1024
    ds_read_b64_tr_b16 v[190:191], v23 offset:9216
    s_waitcnt lgkmcnt(0)
    s_add_u32 s49, s44, 1
    v_mov_b32 v29, s49
    s_mov_b64 exec, 1
    ds_write_b32 v28, v29 offset:64
    s_mov_b64 exec, -1
    v_mfma_f32_16x16x32_bf16 v[192:195], v[128:131], v[48:51], v[192:195]
    v_mfma_f32_16x16x32_bf16 v[196:199], v[132:135], v[48:51], v[196:199]
    v_mfma_f32_16x16x32_bf16 v[200:203], v[136:139], v[48:51], v[200:203]
    v_mfma_f32_16x16x32_bf16 v[204:207], v[140:143], v[48:51], v[204:207]
    v_mfma_f32_16x16x32_bf16 v[208:211], v[144:147], v[48:51], v[208:211]
    v_mfma_f32_16x16x32_bf16 v[212:215], v[148:151], v[48:51], v[212:215]
    v_mfma_f32_16x16x32_bf16 v[216:219], v[152:155], v[48:51], v[216:219]
    v_mfma_f32_16x16x32_bf16 v[220:223], v[156:159], v[48:51], v[220:223]
    v_mfma_f32_16x16x32_bf16 v[224:227], v[160:163], v[48:51], v[224:227]
    v_mfma_f32_16x16x32_bf16 v[228:231], v[164:167], v[48:51], v[228:231]
    v_mfma_f32_16x16x32_bf16 v[232:235], v[168:171], v[48:51], v[232:235]
    v_mfma_f32_16x16x32_bf16 v[236:239], v[172:175], v[48:51], v[236:239]
    v_mfma_f32_16x16x32_bf16 v[240:243], v[176:179], v[48:51], v[240:243]
    v_mfma_f32_16x16x32_bf16 v[244:247], v[180:183], v[48:51], v[244:247]
    v_mfma_f32_16x16x32_bf16 v[248:251], v[184:187], v[48:51], v[248:251]
    v_mfma_f32_16x16x32_bf16 v[252:255], v[188:191], v[48:51], v[252:255]
    v_max3_f32 v52, v32, v33, v34
    v_max3_f32 v52, v52, v35, v36
    v_max3_f32 v52, v52, v37, v38
    v_max_f32 v52, v52, v39
    v_fma_f32 v53, v52, s47, -v26
    v_cmp_lt_f32 vcc, s48, v53
    s_nop 1
    s_cmp_lg_u64 vcc, 0
    s_cbranch_scc1 L_rare_35
L_back_36:
    v_fma_f32 v40, v32, s47, -v26
    v_fma_f32 v41, v33, s47, -v26
    v_fma_f32 v42, v34, s47, -v26
    v_fma_f32 v43, v35, s47, -v26
    v_fma_f32 v44, v36, s47, -v26
    v_fma_f32 v45, v37, s47, -v26
    v_fma_f32 v46, v38, s47, -v26
    v_fma_f32 v47, v39, s47, -v26
    v_exp_f32 v40, v40
    v_exp_f32 v41, v41
    v_exp_f32 v42, v42
    v_exp_f32 v43, v43
    v_exp_f32 v44, v44
    v_exp_f32 v45, v45
    v_exp_f32 v46, v46
    v_exp_f32 v47, v47
    s_nop 0
    v_cvt_pk_bf16_f32 v48, v40, v41
    v_cvt_pk_bf16_f32 v49, v42, v43
    v_cvt_pk_bf16_f32 v50, v44, v45
    v_cvt_pk_bf16_f32 v51, v46, v47
    v_add_f32 v40, v40, v41
    v_add_f32 v42, v42, v43
    v_add_f32 v44, v44, v45
    v_add_f32 v46, v46, v47
    v_add_f32 v40, v40, v42
    v_add_f32 v44, v44, v46
    v_add_f32 v27, v27, v40
    v_add_f32 v27, v27, v44
    s_add_u32 s44, s44, 1
    s_add_u32 s45, s45, 16384
    s_cmp_eq_u32 s45, 147456
    s_cselect_b32 s45, 65536, s45
    s_add_u32 s46, s46, 16384
    s_cmp_eq_u32 s46, 65536
    s_cselect_b32 s46, 0, s46
    s_cmp_le_u32 s44, 88
    s_cbranch_scc1 L_c_loop
L_c_last:
    v_mov_b32 v52, v27
    s_nop 1
    v_permlane32_swap_b32 v27, v52
    s_nop 1
    v_add_f32 v27, v27, v52
    v_mov_b32 v52, v27
    s_nop 1
    v_permlane16_swap_b32 v27, v52
    s_nop 1
    v_add_f32 v27, v27, v52
    v_and_b32 v1, 15, v0
    v_lshrrev_b32 v2, 4, v0
    v_lshlrev_b32 v3, 6, v1
    v_lshl_add_u32 v3, v2, 4, v3
    s_mul_i32 s60, s73, 16384
    s_add_u32 s60, s60, 1048576
    s_add_u32 s61, s60, 4096
    s_add_u32 s62, s60, 8192
    v_lshlrev_b32 v55, 4, v1
    v_mov_b32 v4, v26
    v_mov_b32 v5, v27
    v_mov_b32 v6, s64
    v_mov_b32 v7, s64
    v_mov_b32 v54, s65
    s_mov_b64 exec, 0xff
    buffer_store_dwordx4 v[4:7], v55, s[28:31], s62 offen sc1
    s_mov_b64 exec, -1
    s_mov_b32 s32, s12
    s_mov_b32 s33, s13
    s_mov_b32 s34, 3670016
    s_mov_b32 s35, 0x20000
    s_lshl_b32 s56, s43, 2
    s_add_u32 s56, s56, s41
    s_mul_i32 s56, s56, 114688
    s_mul_i32 s53, s3, 224
    s_add_u32 s56, s56, s53
    v_lshrrev_b32 v60, 4, v0
    v_mul_u32_u24 v60, 3584, v60
    v_and_b32 v61, 15, v0
    v_lshl_add_u32 v60, v61, 4, v60
    s_mov_b32 s54, 0x05040100
    s_mov_b32 s55, 0x07060302
    s_add_u32 s53, s56, 0
    buffer_load_dwordx4 v[64:67], v60, s[32:35], s53 offen
    s_add_u32 s53, s56, 896
    buffer_load_dwordx4 v[68:71], v60, s[32:35], s53 offen
    s_add_u32 s53, s56, 1792
    buffer_load_dwordx4 v[72:75], v60, s[32:35], s53 offen
    s_add_u32 s53, s56, 2688
    buffer_load_dwordx4 v[76:79], v60, s[32:35], s53 offen
    s_add_u32 s53, s56, 14336
    buffer_load_dwordx4 v[80:83], v60, s[32:35], s53 offen
    s_add_u32 s53, s56, 15232
    buffer_load_dwordx4 v[84:87], v60, s[32:35], s53 offen
    s_add_u32 s53, s56, 16128
    buffer_load_dwordx4 v[88:91], v60, s[32:35], s53 offen
    s_add_u32 s53, s56, 17024
    buffer_load_dwordx4 v[92:95], v60, s[32:35], s53 offen
    s_add_u32 s53, s56, 28672
    buffer_load_dwordx4 v[96:99], v60, s[32:35], s53 offen
    s_add_u32 s53, s56, 29568
    buffer_load_dwordx4 v[100:103], v60, s[32:35], s53 offen
    s_add_u32 s53, s56, 30464
    buffer_load_dwordx4 v[104:107], v60, s[32:35], s53 offen
    s_add_u32 s53, s56, 31360
    buffer_load_dwordx4 v[108:111], v60, s[32:35], s53 offen
    s_add_u32 s53, s56, 43008
    buffer_load_dwordx4 v[112:115], v60, s[32:35], s53 offen
    s_add_u32 s53, s56, 43904
    buffer_load_dwordx4 v[116:119], v60, s[32:35], s53 offen
    s_add_u32 s53, s56, 44800
    buffer_load_dwordx4 v[120:123], v60, s[32:35], s53 offen
    s_add_u32 s53, s56, 45696
    buffer_load_dwordx4 v[124:127], v60, s[32:35], s53 offen
    s_add_u32 s53, s56, 57344
    buffer_load_dwordx4 a[160:163], v60, s[32:35], s53 offen
    s_add_u32 s53, s56, 58240
    buffer_load_dwordx4 a[164:167], v60, s[32:35], s53 offen
    s_add_u32 s53, s56, 59136
    buffer_load_dwordx4 a[168:171], v60, s[32:35], s53 offen
    s_add_u32 s53, s56, 60032
    buffer_load_dwordx4 a[172:175], v60, s[32:35], s53 offen
    s_add_u32 s53, s56, 71680
    buffer_load_dwordx4 a[176:179], v60, s[32:35], s53 offen
    s_add_u32 s53, s56, 72576
    buffer_load_dwordx4 a[180:183], v60, s[32:35], s53 offen
    s_add_u32 s53, s56, 73472
    buffer_load_dwordx4 a[184:187], v60, s[32:35], s53 offen
    s_add_u32 s53, s56, 74368
    buffer_load_dwordx4 a[188:191], v60, s[32:35], s53 offen
    s_add_u32 s53, s56, 86016
    buffer_load_dwordx4 a[192:195], v60, s[32:35], s53 offen
    s_add_u32 s53, s56, 86912
    buffer_load_dwordx4 a[196:199], v60, s[32:35], s53 offen
    s_add_u32 s53, s56, 87808
    buffer_load_dwordx4 a[200:203], v60, s[32:35], s53 offen
    s_add_u32 s53, s56, 88704
    buffer_load_dwordx4 a[204:207], v60, s[32:35], s53 offen
    s_add_u32 s53, s56, 100352
    buffer_load_dwordx4 a[208:211], v60, s[32:35], s53 offen
    s_add_u32 s53, s56, 101248
    buffer_load_dwordx4 a[212:215], v60, s[32:35], s53 offen
    s_add_u32 s53, s56, 102144
    buffer_load_dwordx4 a[216:219], v60, s[32:35], s53 offen
    s_add_u32 s53, s56, 103040
    buffer_load_dwordx4 a[220:223], v60, s[32:35], s53 offen
    v_add_u32 v16, s46, v8
    v_add_u32 v17, s46, v9
    v_add_u32 v18, s46, v10
    v_add_u32 v19, s46, v11
    v_add_u32 v20, s46, v12
    v_add_u32 v21, s46, v13
    v_add_u32 v22, s46, v14
    v_add_u32 v23, s46, v15
    v_mov_b32 v62, 161792
    s_mov_b32 s52, 262144
L_wc_37:
    ds_read_b32 v63, v62 offset:40
    s_sub_u32 s52, s52, 1
    s_cbranch_scc1 L_wcx_38
    s_waitcnt lgkmcnt(0)
    v_readfirstlane_b32 s50, v63
    s_cmp_ge_u32 s50, 1
    s_cbranch_scc1 L_wcx_38
    s_branch L_wc_37
L_wcx_38:
    s_waitcnt lgkmcnt(0)
    ds_read_b64_tr_b16 v[128:129], v16 offset:0
    ds_read_b64_tr_b16 v[130:131], v16 offset:8192
    ds_read_b64_tr_b16 v[132:133], v17 offset:0
    ds_read_b64_tr_b16 v[134:135], v17 offset:8192
    ds_read_b64_tr_b16 v[136:137], v18 offset:0
    ds_read_b64_tr_b16 v[138:139], v18 offset:8192
    ds_read_b64_tr_b16 v[140:141], v19 offset:0
    ds_read_b64_tr_b16 v[142:143], v19 offset:8192
    ds_read_b64_tr_b16 v[144:145], v20 offset:0
    ds_read_b64_tr_b16 v[146:147], v20 offset:8192
    ds_read_b64_tr_b16 v[148:149], v21 offset:0
    ds_read_b64_tr_b16 v[150:151], v21 offset:8192
    ds_read_b64_tr_b16 v[152:153], v22 offset:0
    ds_read_b64_tr_b16 v[154:155], v22 offset:8192
    ds_read_b64_tr_b16 v[156:157], v23 offset:0
    ds_read_b64_tr_b16 v[158:159], v23 offset:8192
    s_waitcnt lgkmcnt(0)
    v_mfma_f32_16x16x32_bf16 v[192:195], v[128:131], v[48:51], v[192:195]
    v_mfma_f32_16x16x32_bf16 v[196:199], v[132:135], v[48:51], v[196:199]
    v_mfma_f32_16x16x32_bf16 v[200:203], v[136:139], v[48:51], v[200:203]
    v_mfma_f32_16x16x32_bf16 v[204:207], v[140:143], v[48:51], v[204:207]
    v_mfma_f32_16x16x32_bf16 v[208:211], v[144:147], v[48:51], v[208:211]
    v_mfma_f32_16x16x32_bf16 v[212:215], v[148:151], v[48:51], v[212:215]
    v_mfma_f32_16x16x32_bf16 v[216:219], v[152:155], v[48:51], v[216:219]
    v_mfma_f32_16x16x32_bf16 v[220:223], v[156:159], v[48:51], v[220:223]
    s_nop 6
    s_mov_b32 exec_lo, 0x00ff00ff
    s_mov_b32 exec_hi, 0x00ff00ff
    v_and_or_b32 v192, v192, s66, v54
    v_and_or_b32 v193, v193, s66, v54
    v_and_or_b32 v194, v194, s66, v54
    v_and_or_b32 v195, v195, s66, v54
    buffer_store_dwordx4 v[192:195], v3, s[28:31], s60 offen offset:0 sc1
    v_and_or_b32 v196, v196, s66, v54
    v_and_or_b32 v197, v197, s66, v54
    v_and_or_b32 v198, v198, s66, v54
    v_and_or_b32 v199, v199, s66, v54
    buffer_store_dwordx4 v[196:199], v3, s[28:31], s60 offen offset:512 sc1
    v_and_or_b32 v200, v200, s66, v54
    v_and_or_b32 v201, v201, s66, v54
    v_and_or_b32 v202, v202, s66, v54
    v_and_or_b32 v203, v203, s66, v54
    buffer_store_dwordx4 v[200:203], v3, s[28:31], s60 offen offset:1024 sc1
    v_and_or_b32 v204, v204, s66, v54
    v_and_or_b32 v205, v205, s66, v54
    v_and_or_b32 v206, v206, s66, v54
    v_and_or_b32 v207, v207, s66, v54
    buffer_store_dwordx4 v[204:207], v3, s[28:31], s60 offen offset:1536 sc1
    v_and_or_b32 v208, v208, s66, v54
    v_and_or_b32 v209, v209, s66, v54
    v_and_or_b32 v210, v210, s66, v54
    v_and_or_b32 v211, v211, s66, v54
    buffer_store_dwordx4 v[208:211], v3, s[28:31], s60 offen offset:2048 sc1
    v_and_or_b32 v212, v212, s66, v54
    v_and_or_b32 v213, v213, s66, v54
    v_and_or_b32 v214, v214, s66, v54
    v_and_or_b32 v215, v215, s66, v54
    buffer_store_dwordx4 v[212:215], v3, s[28:31], s60 offen offset:2560 sc1
    v_and_or_b32 v216, v216, s66, v54
    v_and_or_b32 v217, v217, s66, v54
    v_and_or_b32 v218, v218, s66, v54
    v_and_or_b32 v219, v219, s66, v54
    buffer_store_dwordx4 v[216:219], v3, s[28:31], s60 offen offset:3072 sc1
    v_and_or_b32 v220, v220, s66, v54
    v_and_or_b32 v221, v221, s66, v54
    v_and_or_b32 v222, v222, s66, v54
    v_and_or_b32 v223, v223, s66, v54
    buffer_store_dwordx4 v[220:223], v3, s[28:31], s60 offen offset:3584 sc1
    s_mov_b64 exec, -1
    s_add_u32 s49, s44, 1
    s_mov_b32 s52, 262144
L_lpoll_39:
    ds_read_b64 v[62:63], v28 offset:0
    s_sub_u32 s52, s52, 1
    s_cbranch_scc1 L_lpollx_40
    s_waitcnt lgkmcnt(0)
    v_readfirstlane_b32 s50, v62
    s_cmp_ge_u32 s50, s49
    s_cbranch_scc1 L_lpollx_40
    s_sleep 1
    s_branch L_lpoll_39
L_lpollx_40:
    s_waitcnt lgkmcnt(0)
    ds_read_b64_tr_b16 v[160:161], v16 offset:1024
    ds_read_b64_tr_b16 v[162:163], v16 offset:9216
    ds_read_b64_tr_b16 v[164:165], v17 offset:1024
    ds_read_b64_tr_b16 v[166:167], v17 offset:9216
    ds_read_b64_tr_b16 v[168:169], v18 offset:1024
    ds_read_b64_tr_b16 v[170:171], v18 offset:9216
    ds_read_b64_tr_b16 v[172:173], v19 offset:1024
    ds_read_b64_tr_b16 v[174:175], v19 offset:9216
    ds_read_b64_tr_b16 v[176:177], v20 offset:1024
    ds_read_b64_tr_b16 v[178:179], v20 offset:9216
    ds_read_b64_tr_b16 v[180:181], v21 offset:1024
    ds_read_b64_tr_b16 v[182:183], v21 offset:9216
    ds_read_b64_tr_b16 v[184:185], v22 offset:1024
    ds_read_b64_tr_b16 v[186:187], v22 offset:9216
    ds_read_b64_tr_b16 v[188:189], v23 offset:1024
    ds_read_b64_tr_b16 v[190:191], v23 offset:9216
    s_waitcnt lgkmcnt(0)
    v_mfma_f32_16x16x32_bf16 v[224:227], v[160:163], v[48:51], v[224:227]
    v_mfma_f32_16x16x32_bf16 v[228:231], v[164:167], v[48:51], v[228:231]
    v_mfma_f32_16x16x32_bf16 v[232:235], v[168:171], v[48:51], v[232:235]
    v_mfma_f32_16x16x32_bf16 v[236:239], v[172:175], v[48:51], v[236:239]
    v_mfma_f32_16x16x32_bf16 v[240:243], v[176:179], v[48:51], v[240:243]
    v_mfma_f32_16x16x32_bf16 v[244:247], v[180:183], v[48:51], v[244:247]
    v_mfma_f32_16x16x32_bf16 v[248:251], v[184:187], v[48:51], v[248:251]
    v_mfma_f32_16x16x32_bf16 v[252:255], v[188:191], v[48:51], v[252:255]
    s_nop 6
    s_mov_b32 exec_lo, 0x00ff00ff
    s_mov_b32 exec_hi, 0x00ff00ff
    v_and_or_b32 v224, v224, s66, v54
    v_and_or_b32 v225, v225, s66, v54
    v_and_or_b32 v226, v226, s66, v54
    v_and_or_b32 v227, v227, s66, v54
    buffer_store_dwordx4 v[224:227], v3, s[28:31], s61 offen offset:0 sc1
    v_and_or_b32 v228, v228, s66, v54
    v_and_or_b32 v229, v229, s66, v54
    v_and_or_b32 v230, v230, s66, v54
    v_and_or_b32 v231, v231, s66, v54
    buffer_store_dwordx4 v[228:231], v3, s[28:31], s61 offen offset:512 sc1
    v_and_or_b32 v232, v232, s66, v54
    v_and_or_b32 v233, v233, s66, v54
    v_and_or_b32 v234, v234, s66, v54
    v_and_or_b32 v235, v235, s66, v54
    buffer_store_dwordx4 v[232:235], v3, s[28:31], s61 offen offset:1024 sc1
    v_and_or_b32 v236, v236, s66, v54
    v_and_or_b32 v237, v237, s66, v54
    v_and_or_b32 v238, v238, s66, v54
    v_and_or_b32 v239, v239, s66, v54
    buffer_store_dwordx4 v[236:239], v3, s[28:31], s61 offen offset:1536 sc1
    v_and_or_b32 v240, v240, s66, v54
    v_and_or_b32 v241, v241, s66, v54
    v_and_or_b32 v242, v242, s66, v54
    v_and_or_b32 v243, v243, s66, v54
    buffer_store_dwordx4 v[240:243], v3, s[28:31], s61 offen offset:2048 sc1
    v_and_or_b32 v244, v244, s66, v54
    v_and_or_b32 v245, v245, s66, v54
    v_and_or_b32 v246, v246, s66, v54
    v_and_or_b32 v247, v247, s66, v54
    buffer_store_dwordx4 v[244:247], v3, s[28:31], s61 offen offset:2560 sc1
    v_and_or_b32 v248, v248, s66, v54
    v_and_or_b32 v249, v249, s66, v54
    v_and_or_b32 v250, v250, s66, v54
    v_and_or_b32 v251, v251, s66, v54
    buffer_store_dwordx4 v[248:251], v3, s[28:31], s61 offen offset:3072 sc1
    v_and_or_b32 v252, v252, s66, v54
    v_and_or_b32 v253, v253, s66, v54
    v_and_or_b32 v254, v254, s66, v54
    v_and_or_b32 v255, v255, s66, v54
    buffer_store_dwordx4 v[252:255], v3, s[28:31], s61 offen offset:3584 sc1
    v_mov_b32 v29, 1
    s_mov_b64 exec, 1
    ds_write_b32 v28, v29 offset:120
    s_mov_b64 exec, -1
    s_waitcnt vmcnt(40)
    v_perm_b32 v56, v68, v64, s54
    v_accvgpr_write_b32 a32, v56
    v_perm_b32 v57, v76, v72, s54
    v_accvgpr_write_b32 a33, v57
    v_perm_b32 v58, v84, v80, s54
    v_accvgpr_write_b32 a34, v58
    v_perm_b32 v59, v92, v88, s54
    v_accvgpr_write_b32 a35, v59
    v_perm_b32 v56, v68, v64, s55
    v_accvgpr_write_b32 a48, v56
    v_perm_b32 v57, v76, v72, s55
    v_accvgpr_write_b32 a49, v57
    v_perm_b32 v58, v84, v80, s55
    v_accvgpr_write_b32 a50, v58
    v_perm_b32 v59, v92, v88, s55
    v_accvgpr_write_b32 a51, v59
    v_perm_b32 v56, v69, v65, s54
    v_accvgpr_write_b32 a64, v56
    v_perm_b32 v57, v77, v73, s54
    v_accvgpr_write_b32 a65, v57
    v_perm_b32 v58, v85, v81, s54
    v_accvgpr_write_b32 a66, v58
    v_perm_b32 v59, v93, v89, s54
    v_accvgpr_write_b32 a67, v59
    v_perm_b32 v56, v69, v65, s55
    v_accvgpr_write_b32 a80, v56
    v_perm_b32 v57, v77, v73, s55
    v_accvgpr_write_b32 a81, v57
    v_perm_b32 v58, v85, v81, s55
    v_accvgpr_write_b32 a82, v58
    v_perm_b32 v59, v93, v89, s55
    v_accvgpr_write_b32 a83, v59
    v_perm_b32 v56, v70, v66, s54
    v_accvgpr_write_b32 a96, v56
    v_perm_b32 v57, v78, v74, s54
    v_accvgpr_write_b32 a97, v57
    v_perm_b32 v58, v86, v82, s54
    v_accvgpr_write_b32 a98, v58
    v_perm_b32 v59, v94, v90, s54
    v_accvgpr_write_b32 a99, v59
    v_perm_b32 v56, v70, v66, s55
    v_accvgpr_write_b32 a112, v56
    v_perm_b32 v57, v78, v74, s55
    v_accvgpr_write_b32 a113, v57
    v_perm_b32 v58, v86, v82, s55
    v_accvgpr_write_b32 a114, v58
    v_perm_b32 v59, v94, v90, s55
    v_accvgpr_write_b32 a115, v59
    v_perm_b32 v56, v71, v67, s54
    v_accvgpr_write_b32 a128, v56
    v_perm_b32 v57, v79, v75, s54
    v_accvgpr_write_b32 a129, v57
    v_perm_b32 v58, v87, v83, s54
    v_accvgpr_write_b32 a130, v58
    v_perm_b32 v59, v95, v91, s54
    v_accvgpr_write_b32 a131, v59
    v_perm_b32 v56, v71, v67, s55
    v_accvgpr_write_b32 a144, v56
    v_perm_b32 v57, v79, v75, s55
    v_accvgpr_write_b32 a145, v57
    v_perm_b32 v58, v87, v83, s55
    v_accvgpr_write_b32 a146, v58
    v_perm_b32 v59, v95, v91, s55
    v_accvgpr_write_b32 a147, v59
    s_waitcnt vmcnt(32)
    v_perm_b32 v56, v100, v96, s54
    v_accvgpr_write_b32 a36, v56
    v_perm_b32 v57, v108, v104, s54
    v_accvgpr_write_b32 a37, v57
    v_perm_b32 v58, v116, v112, s54
    v_accvgpr_write_b32 a38, v58
    v_perm_b32 v59, v124, v120, s54
    v_accvgpr_write_b32 a39, v59
    v_perm_b32 v56, v100, v96, s55
    v_accvgpr_write_b32 a52, v56
    v_perm_b32 v57, v108, v104, s55
    v_accvgpr_write_b32 a53, v57
    v_perm_b32 v58, v116, v112, s55
    v_accvgpr_write_b32 a54, v58
    v_perm_b32 v59, v124, v120, s55
    v_accvgpr_write_b32 a55, v59
    v_perm_b32 v56, v101, v97, s54
    v_accvgpr_write_b32 a68, v56
    v_perm_b32 v57, v109, v105, s54
    v_accvgpr_write_b32 a69, v57
    v_perm_b32 v58, v117, v113, s54
    v_accvgpr_write_b32 a70, v58
    v_perm_b32 v59, v125, v121, s54
    v_accvgpr_write_b32 a71, v59
    v_perm_b32 v56, v101, v97, s55
    v_accvgpr_write_b32 a84, v56
    v_perm_b32 v57, v109, v105, s55
    v_accvgpr_write_b32 a85, v57
    v_perm_b32 v58, v117, v113, s55
    v_accvgpr_write_b32 a86, v58
    v_perm_b32 v59, v125, v121, s55
    v_accvgpr_write_b32 a87, v59
    v_perm_b32 v56, v102, v98, s54
    v_accvgpr_write_b32 a100, v56
    v_perm_b32 v57, v110, v106, s54
    v_accvgpr_write_b32 a101, v57
    v_perm_b32 v58, v118, v114, s54
    v_accvgpr_write_b32 a102, v58
    v_perm_b32 v59, v126, v122, s54
    v_accvgpr_write_b32 a103, v59
    v_perm_b32 v56, v102, v98, s55
    v_accvgpr_write_b32 a116, v56
    v_perm_b32 v57, v110, v106, s55
    v_accvgpr_write_b32 a117, v57
    v_perm_b32 v58, v118, v114, s55
    v_accvgpr_write_b32 a118, v58
    v_perm_b32 v59, v126, v122, s55
    v_accvgpr_write_b32 a119, v59
    v_perm_b32 v56, v103, v99, s54
    v_accvgpr_write_b32 a132, v56
    v_perm_b32 v57, v111, v107, s54
    v_accvgpr_write_b32 a133, v57
    v_perm_b32 v58, v119, v115, s54
    v_accvgpr_write_b32 a134, v58
    v_perm_b32 v59, v127, v123, s54
    v_accvgpr_write_b32 a135, v59
    v_perm_b32 v56, v103, v99, s55
    v_accvgpr_write_b32 a148, v56
    v_perm_b32 v57, v111, v107, s55
    v_accvgpr_write_b32 a149, v57
    v_perm_b32 v58, v119, v115, s55
    v_accvgpr_write_b32 a150, v58
    v_perm_b32 v59, v127, v123, s55
    v_accvgpr_write_b32 a151, v59
    s_waitcnt vmcnt(24)
    v_accvgpr_read_b32 v128, a160
    v_accvgpr_read_b32 v129, a161
    v_accvgpr_read_b32 v130, a162
    v_accvgpr_read_b32 v131, a163
    v_accvgpr_read_b32 v132, a164
    v_accvgpr_read_b32 v133, a165
    v_accvgpr_read_b32 v134, a166
    v_accvgpr_read_b32 v135, a167
    v_accvgpr_read_b32 v136, a168
    v_accvgpr_read_b32 v137, a169
    v_accvgpr_read_b32 v138, a170
    v_accvgpr_read_b32 v139, a171
    v_accvgpr_read_b32 v140, a172
    v_accvgpr_read_b32 v141, a173
    v_accvgpr_read_b32 v142, a174
    v_accvgpr_read_b32 v143, a175
    v_accvgpr_read_b32 v144, a176
    v_accvgpr_read_b32 v145, a177
    v_accvgpr_read_b32 v146, a178
    v_accvgpr_read_b32 v147, a179
    v_accvgpr_read_b32 v148, a180
    v_accvgpr_read_b32 v149, a181
    v_accvgpr_read_b32 v150, a182
    v_accvgpr_read_b32 v151, a183
    v_accvgpr_read_b32 v152, a184
    v_accvgpr_read_b32 v153, a185
    v_accvgpr_read_b32 v154, a186
    v_accvgpr_read_b32 v155, a187
    v_accvgpr_read_b32 v156, a188
    v_accvgpr_read_b32 v157, a189
    v_accvgpr_read_b32 v158, a190
    v_accvgpr_read_b32 v159, a191
    v_perm_b32 v56, v132, v128, s54
    v_accvgpr_write_b32 a40, v56
    v_perm_b32 v57, v140, v136, s54
    v_accvgpr_write_b32 a41, v57
    v_perm_b32 v58, v148, v144, s54
    v_accvgpr_write_b32 a42, v58
    v_perm_b32 v59, v156, v152, s54
    v_accvgpr_write_b32 a43, v59
    v_perm_b32 v56, v132, v128, s55
    v_accvgpr_write_b32 a56, v56
    v_perm_b32 v57, v140, v136, s55
    v_accvgpr_write_b32 a57, v57
    v_perm_b32 v58, v148, v144, s55
    v_accvgpr_write_b32 a58, v58
    v_perm_b32 v59, v156, v152, s55
    v_accvgpr_write_b32 a59, v59
    v_perm_b32 v56, v133, v129, s54
    v_accvgpr_write_b32 a72, v56
    v_perm_b32 v57, v141, v137, s54
    v_accvgpr_write_b32 a73, v57
    v_perm_b32 v58, v149, v145, s54
    v_accvgpr_write_b32 a74, v58
    v_perm_b32 v59, v157, v153, s54
    v_accvgpr_write_b32 a75, v59
    v_perm_b32 v56, v133, v129, s55
    v_accvgpr_write_b32 a88, v56
    v_perm_b32 v57, v141, v137, s55
    v_accvgpr_write_b32 a89, v57
    v_perm_b32 v58, v149, v145, s55
    v_accvgpr_write_b32 a90, v58
    v_perm_b32 v59, v157, v153, s55
    v_accvgpr_write_b32 a91, v59
    v_perm_b32 v56, v134, v130, s54
    v_accvgpr_write_b32 a104, v56
    v_perm_b32 v57, v142, v138, s54
    v_accvgpr_write_b32 a105, v57
    v_perm_b32 v58, v150, v146, s54
    v_accvgpr_write_b32 a106, v58
    v_perm_b32 v59, v158, v154, s54
    v_accvgpr_write_b32 a107, v59
    v_perm_b32 v56, v134, v130, s55
    v_accvgpr_write_b32 a120, v56
    v_perm_b32 v57, v142, v138, s55
    v_accvgpr_write_b32 a121, v57
    v_perm_b32 v58, v150, v146, s55
    v_accvgpr_write_b32 a122, v58
    v_perm_b32 v59, v158, v154, s55
    v_accvgpr_write_b32 a123, v59
    v_perm_b32 v56, v135, v131, s54
    v_accvgpr_write_b32 a136, v56
    v_perm_b32 v57, v143, v139, s54
    v_accvgpr_write_b32 a137, v57
    v_perm_b32 v58, v151, v147, s54
    v_accvgpr_write_b32 a138, v58
    v_perm_b32 v59, v159, v155, s54
    v_accvgpr_write_b32 a139, v59
    v_perm_b32 v56, v135, v131, s55
    v_accvgpr_write_b32 a152, v56
    v_perm_b32 v57, v143, v139, s55
    v_accvgpr_write_b32 a153, v57
    v_perm_b32 v58, v151, v147, s55
    v_accvgpr_write_b32 a154, v58
    v_perm_b32 v59, v159, v155, s55
    v_accvgpr_write_b32 a155, v59
    s_waitcnt vmcnt(16)
    v_accvgpr_read_b32 v160, a192
    v_accvgpr_read_b32 v161, a193
    v_accvgpr_read_b32 v162, a194
    v_accvgpr_read_b32 v163, a195
    v_accvgpr_read_b32 v164, a196
    v_accvgpr_read_b32 v165, a197
    v_accvgpr_read_b32 v166, a198
    v_accvgpr_read_b32 v167, a199
    v_accvgpr_read_b32 v168, a200
    v_accvgpr_read_b32 v169, a201
    v_accvgpr_read_b32 v170, a202
    v_accvgpr_read_b32 v171, a203
    v_accvgpr_read_b32 v172, a204
    v_accvgpr_read_b32 v173, a205
    v_accvgpr_read_b32 v174, a206
    v_accvgpr_read_b32 v175, a207
    v_accvgpr_read_b32 v176, a208
    v_accvgpr_read_b32 v177, a209
    v_accvgpr_read_b32 v178, a210
    v_accvgpr_read_b32 v179, a211
    v_accvgpr_read_b32 v180, a212
    v_accvgpr_read_b32 v181, a213
    v_accvgpr_read_b32 v182, a214
    v_accvgpr_read_b32 v183, a215
    v_accvgpr_read_b32 v184, a216
    v_accvgpr_read_b32 v185, a217
    v_accvgpr_read_b32 v186, a218
    v_accvgpr_read_b32 v187, a219
    v_accvgpr_read_b32 v188, a220
    v_accvgpr_read_b32 v189, a221
    v_accvgpr_read_b32 v190, a222
    v_accvgpr_read_b32 v191, a223
    v_perm_b32 v56, v164, v160, s54
    v_accvgpr_write_b32 a44, v56
    v_perm_b32 v57, v172, v168, s54
    v_accvgpr_write_b32 a45, v57
    v_perm_b32 v58, v180, v176, s54
    v_accvgpr_write_b32 a46, v58
    v_perm_b32 v59, v188, v184, s54
    v_accvgpr_write_b32 a47, v59
    v_perm_b32 v56, v164, v160, s55
    v_accvgpr_write_b32 a60, v56
    v_perm_b32 v57, v172, v168, s55
    v_accvgpr_write_b32 a61, v57
    v_perm_b32 v58, v180, v176, s55
    v_accvgpr_write_b32 a62, v58
    v_perm_b32 v59, v188, v184, s55
    v_accvgpr_write_b32 a63, v59
    v_perm_b32 v56, v165, v161, s54
    v_accvgpr_write_b32 a76, v56
    v_perm_b32 v57, v173, v169, s54
    v_accvgpr_write_b32 a77, v57
    v_perm_b32 v58, v181, v177, s54
    v_accvgpr_write_b32 a78, v58
    v_perm_b32 v59, v189, v185, s54
    v_accvgpr_write_b32 a79, v59
    v_perm_b32 v56, v165, v161, s55
    v_accvgpr_write_b32 a92, v56
    v_perm_b32 v57, v173, v169, s55
    v_accvgpr_write_b32 a93, v57
    v_perm_b32 v58, v181, v177, s55
    v_accvgpr_write_b32 a94, v58
    v_perm_b32 v59, v189, v185, s55
    v_accvgpr_write_b32 a95, v59
    v_perm_b32 v56, v166, v162, s54
    v_accvgpr_write_b32 a108, v56
    v_perm_b32 v57, v174, v170, s54
    v_accvgpr_write_b32 a109, v57
    v_perm_b32 v58, v182, v178, s54
    v_accvgpr_write_b32 a110, v58
    v_perm_b32 v59, v190, v186, s54
    v_accvgpr_write_b32 a111, v59
    v_perm_b32 v56, v166, v162, s55
    v_accvgpr_write_b32 a124, v56
    v_perm_b32 v57, v174, v170, s55
    v_accvgpr_write_b32 a125, v57
    v_perm_b32 v58, v182, v178, s55
    v_accvgpr_write_b32 a126, v58
    v_perm_b32 v59, v190, v186, s55
    v_accvgpr_write_b32 a127, v59
    v_perm_b32 v56, v167, v163, s54
    v_accvgpr_write_b32 a140, v56
    v_perm_b32 v57, v175, v171, s54
    v_accvgpr_write_b32 a141, v57
    v_perm_b32 v58, v183, v179, s54
    v_accvgpr_write_b32 a142, v58
    v_perm_b32 v59, v191, v187, s54
    v_accvgpr_write_b32 a143, v59
    v_perm_b32 v56, v167, v163, s55
    v_accvgpr_write_b32 a156, v56
    v_perm_b32 v57, v175, v171, s55
    v_accvgpr_write_b32 a157, v57
    v_perm_b32 v58, v183, v179, s55
    v_accvgpr_write_b32 a158, v58
    v_perm_b32 v59, v191, v187, s55
    v_accvgpr_write_b32 a159, v59
    s_branch L_tail
L_rare_31:
    s_nop 7
    v_mov_b32 v53, v52
    s_nop 1
    v_permlane32_swap_b32 v52, v53
    s_nop 1
    v_max_f32 v52, v52, v53
    v_mov_b32 v53, v52
    s_nop 1
    v_permlane16_swap_b32 v52, v53
    s_nop 1
    v_max_f32 v52, v52, v53
    v_mul_f32 v52, s47, v52
    v_max_f32 v52, v52, v26
    v_sub_f32 v53, v26, v52
    v_exp_f32 v53, v53
    v_mov_b32 v26, v52
    v_mul_f32 v27, v27, v53
    v_mul_f32 v192, v192, v53
    v_mul_f32 v193, v193, v53
    v_mul_f32 v194, v194, v53
    v_mul_f32 v195, v195, v53
    v_mul_f32 v196, v196, v53
    v_mul_f32 v197, v197, v53
    v_mul_f32 v198, v198, v53
    v_mul_f32 v199, v199, v53
    v_mul_f32 v200, v200, v53
    v_mul_f32 v201, v201, v53
    v_mul_f32 v202, v202, v53
    v_mul_f32 v203, v203, v53
    v_mul_f32 v204, v204, v53
    v_mul_f32 v205, v205, v53
    v_mul_f32 v206, v206, v53
    v_mul_f32 v207, v207, v53
    v_mul_f32 v208, v208, v53
    v_mul_f32 v209, v209, v53
    v_mul_f32 v210, v210, v53
    v_mul_f32 v211, v211, v53
    v_mul_f32 v212, v212, v53
    v_mul_f32 v213, v213, v53
    v_mul_f32 v214, v214, v53
    v_mul_f32 v215, v215, v53
    v_mul_f32 v216, v216, v53
    v_mul_f32 v217, v217, v53
    v_mul_f32 v218, v218, v53
    v_mul_f32 v219, v219, v53
    v_mul_f32 v220, v220, v53
    v_mul_f32 v221, v221, v53
    v_mul_f32 v222, v222, v53
    v_mul_f32 v223, v223, v53
    v_mul_f32 v224, v224, v53
    v_mul_f32 v225, v225, v53
    v_mul_f32 v226, v226, v53
    v_mul_f32 v227, v227, v53
    v_mul_f32 v228, v228, v53
    v_mul_f32 v229, v229, v53
    v_mul_f32 v230, v230, v53
    v_mul_f32 v231, v231, v53
    v_mul_f32 v232, v232, v53
    v_mul_f32 v233, v233, v53
    v_mul_f32 v234, v234, v53
    v_mul_f32 v235, v235, v53
    v_mul_f32 v236, v236, v53
    v_mul_f32 v237, v237, v53
    v_mul_f32 v238, v238, v53
    v_mul_f32 v239, v239, v53
    v_mul_f32 v240, v240, v53
    v_mul_f32 v241, v241, v53
    v_mul_f32 v242, v242, v53
    v_mul_f32 v243, v243, v53
    v_mul_f32 v244, v244, v53
    v_mul_f32 v245, v245, v53
    v_mul_f32 v246, v246, v53
    v_mul_f32 v247, v247, v53
    v_mul_f32 v248, v248, v53
    v_mul_f32 v249, v249, v53
    v_mul_f32 v250, v250, v53
    v_mul_f32 v251, v251, v53
    v_mul_f32 v252, v252, v53
    v_mul_f32 v253, v253, v53
    v_mul_f32 v254, v254, v53
    v_mul_f32 v255, v255, v53
    s_branch L_back_32
L_rare_35:
    s_nop 7
    v_mov_b32 v53, v52
    s_nop 1
    v_permlane32_swap_b32 v52, v53
    s_nop 1
    v_max_f32 v52, v52, v53
    v_mov_b32 v53, v52
    s_nop 1
    v_permlane16_swap_b32 v52, v53
    s_nop 1
    v_max_f32 v52, v52, v53
    v_mul_f32 v52, s47, v52
    v_max_f32 v52, v52, v26
    v_sub_f32 v53, v26, v52
    v_exp_f32 v53, v53
    v_mov_b32 v26, v52
    v_mul_f32 v27, v27, v53
    v_mul_f32 v192, v192, v53
    v_mul_f32 v193, v193, v53
    v_mul_f32 v194, v194, v53
    v_mul_f32 v195, v195, v53
    v_mul_f32 v196, v196, v53
    v_mul_f32 v197, v197, v53
    v_mul_f32 v198, v198, v53
    v_mul_f32 v199, v199, v53
    v_mul_f32 v200, v200, v53
    v_mul_f32 v201, v201, v53
    v_mul_f32 v202, v202, v53
    v_mul_f32 v203, v203, v53
    v_mul_f32 v204, v204, v53
    v_mul_f32 v205, v205, v53
    v_mul_f32 v206, v206, v53
    v_mul_f32 v207, v207, v53
    v_mul_f32 v208, v208, v53
    v_mul_f32 v209, v209, v53
    v_mul_f32 v210, v210, v53
    v_mul_f32 v211, v211, v53
    v_mul_f32 v212, v212, v53
    v_mul_f32 v213, v213, v53
    v_mul_f32 v214, v214, v53
    v_mul_f32 v215, v215, v53
    v_mul_f32 v216, v216, v53
    v_mul_f32 v217, v217, v53
    v_mul_f32 v218, v218, v53
    v_mul_f32 v219, v219, v53
    v_mul_f32 v220, v220, v53
    v_mul_f32 v221, v221, v53
    v_mul_f32 v222, v222, v53
    v_mul_f32 v223, v223, v53
    v_mul_f32 v224, v224, v53
    v_mul_f32 v225, v225, v53
    v_mul_f32 v226, v226, v53
    v_mul_f32 v227, v227, v53
    v_mul_f32 v228, v228, v53
    v_mul_f32 v229, v229, v53
    v_mul_f32 v230, v230, v53
    v_mul_f32 v231, v231, v53
    v_mul_f32 v232, v232, v53
    v_mul_f32 v233, v233, v53
    v_mul_f32 v234, v234, v53
    v_mul_f32 v235, v235, v53
    v_mul_f32 v236, v236, v53
    v_mul_f32 v237, v237, v53
    v_mul_f32 v238, v238, v53
    v_mul_f32 v239, v239, v53
    v_mul_f32 v240, v240, v53
    v_mul_f32 v241, v241, v53
    v_mul_f32 v242, v242, v53
    v_mul_f32 v243, v243, v53
    v_mul_f32 v244, v244, v53
    v_mul_f32 v245, v245, v53
    v_mul_f32 v246, v246, v53
    v_mul_f32 v247, v247, v53
    v_mul_f32 v248, v248, v53
    v_mul_f32 v249, v249, v53
    v_mul_f32 v250, v250, v53
    v_mul_f32 v251, v251, v53
    v_mul_f32 v252, v252, v53
    v_mul_f32 v253, v253, v53
    v_mul_f32 v254, v254, v53
    v_mul_f32 v255, v255, v53
    s_branch L_back_36
L_tail:
    v_lshrrev_b32 v1, 4, v0
    v_bfe_u32 v2, v0, 2, 2
    v_and_b32 v3, 3, v0
    v_lshlrev_b32 v4, 10, v2
    v_lshl_add_u32 v4, v3, 6, v4
    v_lshl_add_u32 v4, v1, 4, v4
    v_lshlrev_b32 v5, 4, v3
    s_and_b32 s44, s73, 0xfc
    s_mul_i32 s44, s44, 16384
    s_add_u32 s44, s44, 1048576
    s_and_b32 s45, s41, 1
    s_lshl_b32 s45, s45, 12
    s_lshr_b32 s46, s41, 1
    s_lshl_b32 s47, s46, 8
    s_add_u32 s45, s45, s47
    s_add_u32 s45, s45, s44
    s_lshl_b32 s46, s46, 6
    s_add_u32 s46, s46, s44
    s_add_u32 s46, s46, 8192
    s_add_u32 s56, s45, 0
    s_add_u32 s60, s46, 0
    s_add_u32 s57, s45, 16384
    s_add_u32 s61, s46, 16384
    s_add_u32 s58, s45, 32768
    s_add_u32 s62, s46, 32768
    s_add_u32 s59, s45, 49152
    s_add_u32 s63, s46, 49152
    s_cmp_lg_u32 s3, 2
    s_cbranch_scc1 L_pick
    v_mov_b32 v62, 161792
    s_mov_b32 s52, 262144
L_wc_41:
    ds_read_b32 v63, v62 offset:120
    s_sub_u32 s52, s52, 1
    s_cbranch_scc1 L_wcx_42
    s_waitcnt lgkmcnt(0)
    v_readfirstlane_b32 s50, v63
    s_cmp_ge_u32 s50, 1
    s_cbranch_scc1 L_wcx_42
    s_branch L_wc_41
L_wcx_42:
    s_waitcnt lgkmcnt(0)
    s_mov_b32 s49, 262144
    s_mov_b32 s48, 0
L_p1_43:
    s_bitcmp1_b32 s48, 0
    s_cbranch_scc1 L_ld_45
    buffer_load_dwordx4 v[96:99], v5, s[28:31], s60 offen sc1
    buffer_load_dwordx4 v[64:67], v4, s[28:31], s56 offen offset:0 sc1
    buffer_load_dwordx4 v[68:71], v4, s[28:31], s56 offen offset:512 sc1
L_ld_45:
    s_bitcmp1_b32 s48, 1
    s_cbranch_scc1 L_ld_46
    buffer_load_dwordx4 v[100:103], v5, s[28:31], s61 offen sc1
    buffer_load_dwordx4 v[72:75], v4, s[28:31], s57 offen offset:0 sc1
    buffer_load_dwordx4 v[76:79], v4, s[28:31], s57 offen offset:512 sc1
L_ld_46:
    s_bitcmp1_b32 s48, 2
    s_cbranch_scc1 L_ld_47
    buffer_load_dwordx4 v[104:107], v5, s[28:31], s62 offen sc1
    buffer_load_dwordx4 v[80:83], v4, s[28:31], s58 offen offset:0 sc1
    buffer_load_dwordx4 v[84:87], v4, s[28:31], s58 offen offset:512 sc1
L_ld_47:
    s_bitcmp1_b32 s48, 3
    s_cbranch_scc1 L_ld_48
    buffer_load_dwordx4 v[108:111], v5, s[28:31], s63 offen sc1
    buffer_load_dwordx4 v[88:91], v4, s[28:31], s59 offen offset:0 sc1
    buffer_load_dwordx4 v[92:95], v4, s[28:31], s59 offen offset:512 sc1
L_ld_48:
    s_waitcnt vmcnt(0)
    s_bitcmp1_b32 s48, 0
    s_cbranch_scc1 L_ck_49
    v_xor_b32 v6, s65, v64
    v_bitop3_b32 v6, v6, v65, s65 bitop3:0xf6
    v_bitop3_b32 v6, v6, v66, s65 bitop3:0xf6
    v_bitop3_b32 v6, v6, v67, s65 bitop3:0xf6
    v_bitop3_b32 v6, v6, v68, s65 bitop3:0xf6
    v_bitop3_b32 v6, v6, v69, s65 bitop3:0xf6
    v_bitop3_b32 v6, v6, v70, s65 bitop3:0xf6
    v_bitop3_b32 v6, v6, v71, s65 bitop3:0xf6
    v_and_b32 v6, 0xfff, v6
    v_bitop3_b32 v6, v6, v98, s64 bitop3:0xf6
    v_bitop3_b32 v6, v6, v99, s64 bitop3:0xf6
    v_cmp_ne_u32 vcc, 0, v6
    s_nop 1
    s_cmp_eq_u64 vcc, 0
    s_cbranch_scc0 L_ck_49
    s_bitset1_b32 s48, 0
L_ck_49:
    s_bitcmp1_b32 s48, 1
    s_cbranch_scc1 L_ck_50
    v_xor_b32 v6, s65, v72
    v_bitop3_b32 v6, v6, v73, s65 bitop3:0xf6
    v_bitop3_b32 v6, v6, v74, s65 bitop3:0xf6
    v_bitop3_b32 v6, v6, v75, s65 bitop3:0xf6
    v_bitop3_b32 v6, v6, v76, s65 bitop3:0xf6
    v_bitop3_b32 v6, v6, v77, s65 bitop3:0xf6
    v_bitop3_b32 v6, v6, v78, s65 bitop3:0xf6
    v_bitop3_b32 v6, v6, v79, s65 bitop3:0xf6
    v_and_b32 v6, 0xfff, v6
    v_bitop3_b32 v6, v6, v102, s64 bitop3:0xf6
    v_bitop3_b32 v6, v6, v103, s64 bitop3:0xf6
    v_cmp_ne_u32 vcc, 0, v6
    s_nop 1
    s_cmp_eq_u64 vcc, 0
    s_cbranch_scc0 L_ck_50
    s_bitset1_b32 s48, 1
L_ck_50:
    s_bitcmp1_b32 s48, 2
    s_cbranch_scc1 L_ck_51
    v_xor_b32 v6, s65, v80
    v_bitop3_b32 v6, v6, v81, s65 bitop3:0xf6
    v_bitop3_b32 v6, v6, v82, s65 bitop3:0xf6
    v_bitop3_b32 v6, v6, v83, s65 bitop3:0xf6
    v_bitop3_b32 v6, v6, v84, s65 bitop3:0xf6
    v_bitop3_b32 v6, v6, v85, s65 bitop3:0xf6
    v_bitop3_b32 v6, v6, v86, s65 bitop3:0xf6
    v_bitop3_b32 v6, v6, v87, s65 bitop3:0xf6
    v_and_b32 v6, 0xfff, v6
    v_bitop3_b32 v6, v6, v106, s64 bitop3:0xf6
    v_bitop3_b32 v6, v6, v107, s64 bitop3:0xf6
    v_cmp_ne_u32 vcc, 0, v6
    s_nop 1
    s_cmp_eq_u64 vcc, 0
    s_cbranch_scc0 L_ck_51
    s_bitset1_b32 s48, 2
L_ck_51:
    s_bitcmp1_b32 s48, 3
    s_cbranch_scc1 L_ck_52
    v_xor_b32 v6, s65, v88
    v_bitop3_b32 v6, v6, v89, s65 bitop3:0xf6
    v_bitop3_b32 v6, v6, v90, s65 bitop3:0xf6
    v_bitop3_b32 v6, v6, v91, s65 bitop3:0xf6
    v_bitop3_b32 v6, v6, v92, s65 bitop3:0xf6
    v_bitop3_b32 v6, v6, v93, s65 bitop3:0xf6
    v_bitop3_b32 v6, v6, v94, s65 bitop3:0xf6
    v_bitop3_b32 v6, v6, v95, s65 bitop3:0xf6
    v_and_b32 v6, 0xfff, v6
    v_bitop3_b32 v6, v6, v110, s64 bitop3:0xf6
    v_bitop3_b32 v6, v6, v111, s64 bitop3:0xf6
    v_cmp_ne_u32 vcc, 0, v6
    s_nop 1
    s_cmp_eq_u64 vcc, 0
    s_cbranch_scc0 L_ck_52
    s_bitset1_b32 s48, 3
L_ck_52:
    s_cmp_eq_u32 s48, 15
    s_cbranch_scc1 L_p1d_44
    s_sleep 1
    s_sub_u32 s49, s49, 1
    s_cmp_lg_u32 s49, 0
    s_cbranch_scc1 L_p1_43
L_p1d_44:
    v_max3_f32 v6, v96, v100, v104
    v_max_f32 v6, v6, v108
    v_sub_f32 v8, v96, v6
    v_sub_f32 v9, v100, v6
    v_sub_f32 v10, v104, v6
    v_sub_f32 v11, v108, v6
    v_exp_f32 v8, v8
    v_exp_f32 v9, v9
    v_exp_f32 v10, v10
    v_exp_f32 v11, v11
    s_nop 0
    v_mul_f32 v7, v8, v97
    v_fma_f32 v7, v9, v101, v7
    v_fma_f32 v7, v10, v105, v7
    v_fma_f32 v7, v11, v109, v7
    v_rcp_f32 v7, v7
    s_nop 0
    v_mul_f32 v12, v8, v7
    v_mul_f32 v13, v9, v7
    v_mul_f32 v14, v10, v7
    v_mul_f32 v15, v11, v7
    v_and_b32 v64, s66, v64
    v_and_b32 v65, s66, v65
    v_and_b32 v66, s66, v66
    v_and_b32 v67, s66, v67
    v_and_b32 v68, s66, v68
    v_and_b32 v69, s66, v69
    v_and_b32 v70, s66, v70
    v_and_b32 v71, s66, v71
    v_and_b32 v72, s66, v72
    v_and_b32 v73, s66, v73
    v_and_b32 v74, s66, v74
    v_and_b32 v75, s66, v75
    v_and_b32 v76, s66, v76
    v_and_b32 v77, s66, v77
    v_and_b32 v78, s66, v78
    v_and_b32 v79, s66, v79
    v_and_b32 v80, s66, v80
    v_and_b32 v81, s66, v81
    v_and_b32 v82, s66, v82
    v_and_b32 v83, s66, v83
    v_and_b32 v84, s66, v84
    v_and_b32 v85, s66, v85
    v_and_b32 v86, s66, v86
    v_and_b32 v87, s66, v87
    v_and_b32 v88, s66, v88
    v_and_b32 v89, s66, v89
    v_and_b32 v90, s66, v90
    v_and_b32 v91, s66, v91
    v_and_b32 v92, s66, v92
    v_and_b32 v93, s66, v93
    v_and_b32 v94, s66, v94
    v_and_b32 v95, s66, v95
    v_mul_f32 v104, v12, v64
    v_mul_f32 v105, v12, v65
    v_mul_f32 v106, v12, v66
    v_mul_f32 v107, v12, v67
    v_mul_f32 v108, v12, v68
    v_mul_f32 v109, v12, v69
    v_mul_f32 v110, v12, v70
    v_mul_f32 v111, v12, v71
    v_fma_f32 v104, v13, v72, v104
    v_fma_f32 v105, v13, v73, v105
    v_fma_f32 v106, v13, v74, v106
    v_fma_f32 v107, v13, v75, v107
    v_fma_f32 v108, v13, v76, v108
    v_fma_f32 v109, v13, v77, v109
    v_fma_f32 v110, v13, v78, v110
    v_fma_f32 v111, v13, v79, v111
    v_fma_f32 v104, v14, v80, v104
    v_fma_f32 v105, v14, v81, v105
    v_fma_f32 v106, v14, v82, v106
    v_fma_f32 v107, v14, v83, v107
    v_fma_f32 v108, v14, v84, v108
    v_fma_f32 v109, v14, v85, v109
    v_fma_f32 v110, v14, v86, v110
    v_fma_f32 v111, v14, v87, v111
    v_fma_f32 v104, v15, v88, v104
    v_fma_f32 v105, v15, v89, v105
    v_fma_f32 v106, v15, v90, v106
    v_fma_f32 v107, v15, v91, v107
    v_fma_f32 v108, v15, v92, v108
    v_fma_f32 v109, v15, v93, v109
    v_fma_f32 v110, v15, v94, v110
    v_fma_f32 v111, v15, v95, v111
    v_cvt_pk_bf16_f32 v112, v104, v105
    v_cvt_pk_bf16_f32 v113, v106, v107
    v_cvt_pk_bf16_f32 v114, v108, v109
    v_cvt_pk_bf16_f32 v115, v110, v111
    v_lshlrev_b32 v6, 4, v0
    v_add_u32 v6, 147456, v6
    ds_write_b128 v6, v[112:115]
    v_mov_b32 v62, 161792
    v_mov_b32 v63, 1
    s_waitcnt lgkmcnt(0)
    s_mov_b64 exec, 1
    ds_write_b32 v62, v63 offset:16
    s_mov_b64 exec, -1
L_pick:
    v_and_b32 v6, 0x33, v0
    v_lshlrev_b32 v6, 4, v6
    v_add_u32 v6, 147456, v6
    v_mov_b32 v62, 161792
    s_mov_b32 s52, 262144
L_wc_53:
    ds_read_b32 v63, v62 offset:16
    s_sub_u32 s52, s52, 1
    s_cbranch_scc1 L_wcx_54
    s_waitcnt lgkmcnt(0)
    v_readfirstlane_b32 s50, v63
    s_cmp_ge_u32 s50, 1
    s_cbranch_scc1 L_wcx_54
    s_branch L_wc_53
L_wcx_54:
    s_waitcnt lgkmcnt(0)
    ds_read_b128 v[112:115], v6 offset:0
    ds_read_b128 v[116:119], v6 offset:64
    ds_read_b128 v[120:123], v6 offset:128
    ds_read_b128 v[124:127], v6 offset:192
    s_waitcnt lgkmcnt(0)
    v_mfma_f32_16x16x32_bf16 v[128:131], a[32:35], v[112:115], 0
    v_mfma_f32_16x16x32_bf16 v[132:135], a[48:51], v[112:115], 0
    v_mfma_f32_16x16x32_bf16 v[136:139], a[64:67], v[112:115], 0
    v_mfma_f32_16x16x32_bf16 v[140:143], a[80:83], v[112:115], 0
    v_mfma_f32_16x16x32_bf16 v[144:147], a[96:99], v[112:115], 0
    v_mfma_f32_16x16x32_bf16 v[148:151], a[112:115], v[112:115], 0
    v_mfma_f32_16x16x32_bf16 v[152:155], a[128:131], v[112:115], 0
    v_mfma_f32_16x16x32_bf16 v[156:159], a[144:147], v[112:115], 0
    v_mfma_f32_16x16x32_bf16 v[128:131], a[36:39], v[116:119], v[128:131]
    v_mfma_f32_16x16x32_bf16 v[132:135], a[52:55], v[116:119], v[132:135]
    v_mfma_f32_16x16x32_bf16 v[136:139], a[68:71], v[116:119], v[136:139]
    v_mfma_f32_16x16x32_bf16 v[140:143], a[84:87], v[116:119], v[140:143]
    v_mfma_f32_16x16x32_bf16 v[144:147], a[100:103], v[116:119], v[144:147]
    v_mfma_f32_16x16x32_bf16 v[148:151], a[116:119], v[116:119], v[148:151]
    v_mfma_f32_16x16x32_bf16 v[152:155], a[132:135], v[116:119], v[152:155]
    v_mfma_f32_16x16x32_bf16 v[156:159], a[148:151], v[116:119], v[156:159]
    v_mfma_f32_16x16x32_bf16 v[128:131], a[40:43], v[120:123], v[128:131]
    v_mfma_f32_16x16x32_bf16 v[132:135], a[56:59], v[120:123], v[132:135]
    v_mfma_f32_16x16x32_bf16 v[136:139], a[72:75], v[120:123], v[136:139]
    v_mfma_f32_16x16x32_bf16 v[140:143], a[88:91], v[120:123], v[140:143]
    v_mfma_f32_16x16x32_bf16 v[144:147], a[104:107], v[120:123], v[144:147]
    v_mfma_f32_16x16x32_bf16 v[148:151], a[120:123], v[120:123], v[148:151]
    v_mfma_f32_16x16x32_bf16 v[152:155], a[136:139], v[120:123], v[152:155]
    v_mfma_f32_16x16x32_bf16 v[156:159], a[152:155], v[120:123], v[156:159]
    v_mfma_f32_16x16x32_bf16 v[128:131], a[44:47], v[124:127], v[128:131]
    v_mfma_f32_16x16x32_bf16 v[132:135], a[60:63], v[124:127], v[132:135]
    v_mfma_f32_16x16x32_bf16 v[136:139], a[76:79], v[124:127], v[136:139]
    v_mfma_f32_16x16x32_bf16 v[140:143], a[92:95], v[124:127], v[140:143]
    v_mfma_f32_16x16x32_bf16 v[144:147], a[108:111], v[124:127], v[144:147]
    v_mfma_f32_16x16x32_bf16 v[148:151], a[124:127], v[124:127], v[148:151]
    v_mfma_f32_16x16x32_bf16 v[152:155], a[140:143], v[124:127], v[152:155]
    v_mfma_f32_16x16x32_bf16 v[156:159], a[156:159], v[124:127], v[156:159]
    v_lshlrev_b32 v6, 6, v1
    v_lshl_add_u32 v6, v3, 4, v6
    s_mul_i32 s44, s73, 8192
    s_add_u32 s44, s44, 5242880
    s_and_b32 s46, s3, 1
    s_lshl_b32 s46, s46, 10
    s_add_u32 s46, s46, s44
    s_add_u32 s46, s46, 2048
    s_lshl_b32 s45, s3, 11
    s_add_u32 s44, s44, s45
    s_mov_b32 exec_lo, 0x000f000f
    s_mov_b32 exec_hi, 0x000f000f
    s_nop 4
    v_mov_b32 v7, s65
    v_and_or_b32 v128, v128, s66, v7
    v_and_or_b32 v129, v129, s66, v7
    v_and_or_b32 v130, v130, s66, v7
    v_and_or_b32 v131, v131, s66, v7
    buffer_store_dwordx4 v[128:131], v6, s[28:31], s44 offen offset:0 sc1
    v_and_or_b32 v132, v132, s66, v7
    v_and_or_b32 v133, v133, s66, v7
    v_and_or_b32 v134, v134, s66, v7
    v_and_or_b32 v135, v135, s66, v7
    buffer_store_dwordx4 v[132:135], v6, s[28:31], s44 offen offset:256 sc1
    v_and_or_b32 v136, v136, s66, v7
    v_and_or_b32 v137, v137, s66, v7
    v_and_or_b32 v138, v138, s66, v7
    v_and_or_b32 v139, v139, s66, v7
    buffer_store_dwordx4 v[136:139], v6, s[28:31], s44 offen offset:512 sc1
    v_and_or_b32 v140, v140, s66, v7
    v_and_or_b32 v141, v141, s66, v7
    v_and_or_b32 v142, v142, s66, v7
    v_and_or_b32 v143, v143, s66, v7
    buffer_store_dwordx4 v[140:143], v6, s[28:31], s44 offen offset:768 sc1
    v_and_or_b32 v144, v144, s66, v7
    v_and_or_b32 v145, v145, s66, v7
    v_and_or_b32 v146, v146, s66, v7
    v_and_or_b32 v147, v147, s66, v7
    buffer_store_dwordx4 v[144:147], v6, s[28:31], s44 offen offset:1024 sc1
    v_and_or_b32 v148, v148, s66, v7
    v_and_or_b32 v149, v149, s66, v7
    v_and_or_b32 v150, v150, s66, v7
    v_and_or_b32 v151, v151, s66, v7
    buffer_store_dwordx4 v[148:151], v6, s[28:31], s44 offen offset:1280 sc1
    v_and_or_b32 v152, v152, s66, v7
    v_and_or_b32 v153, v153, s66, v7
    v_and_or_b32 v154, v154, s66, v7
    v_and_or_b32 v155, v155, s66, v7
    buffer_store_dwordx4 v[152:155], v6, s[28:31], s44 offen offset:1536 sc1
    v_and_or_b32 v156, v156, s66, v7
    v_and_or_b32 v157, v157, s66, v7
    v_and_or_b32 v158, v158, s66, v7
    v_and_or_b32 v159, v159, s66, v7
    buffer_store_dwordx4 v[156:159], v6, s[28:31], s44 offen offset:1792 sc1
    s_mov_b64 exec, -1
    s_cmp_lg_u32 s3, 3
    s_cbranch_scc1 L_fin
    v_lshlrev_b32 v4, 2, v0
    s_and_b32 s44, s73, 31
    s_lshl_b32 s45, s44, 8
    s_mul_i32 s46, s42, 262144
    s_add_u32 s45, s45, s46
    s_add_u32 s45, s45, 5242880
    s_mov_b32 s49, 262144
L_p3_56:
    s_mov_b32 s46, s45
    buffer_load_dword v64, v4, s[28:31], s46 offen sc1
    s_add_u32 s46, s46, 8192
    buffer_load_dword v65, v4, s[28:31], s46 offen sc1
    s_add_u32 s46, s46, 8192
    buffer_load_dword v66, v4, s[28:31], s46 offen sc1
    s_add_u32 s46, s46, 8192
    buffer_load_dword v67, v4, s[28:31], s46 offen sc1
    s_add_u32 s46, s46, 8192
    buffer_load_dword v68, v4, s[28:31], s46 offen sc1
    s_add_u32 s46, s46, 8192
    buffer_load_dword v69, v4, s[28:31], s46 offen sc1
    s_add_u32 s46, s46, 8192
    buffer_load_dword v70, v4, s[28:31], s46 offen sc1
    s_add_u32 s46, s46, 8192
    buffer_load_dword v71, v4, s[28:31], s46 offen sc1
    s_add_u32 s46, s46, 8192
    buffer_load_dword v72, v4, s[28:31], s46 offen sc1
    s_add_u32 s46, s46, 8192
    buffer_load_dword v73, v4, s[28:31], s46 offen sc1
    s_add_u32 s46, s46, 8192
    buffer_load_dword v74, v4, s[28:31], s46 offen sc1
    s_add_u32 s46, s46, 8192
    buffer_load_dword v75, v4, s[28:31], s46 offen sc1
    s_add_u32 s46, s46, 8192
    buffer_load_dword v76, v4, s[28:31], s46 offen sc1
    s_add_u32 s46, s46, 8192
    buffer_load_dword v77, v4, s[28:31], s46 offen sc1
    s_add_u32 s46, s46, 8192
    buffer_load_dword v78, v4, s[28:31], s46 offen sc1
    s_add_u32 s46, s46, 8192
    buffer_load_dword v79, v4, s[28:31], s46 offen sc1
    s_add_u32 s46, s46, 8192
    buffer_load_dword v80, v4, s[28:31], s46 offen sc1
    s_add_u32 s46, s46, 8192
    buffer_load_dword v81, v4, s[28:31], s46 offen sc1
    s_add_u32 s46, s46, 8192
    buffer_load_dword v82, v4, s[28:31], s46 offen sc1
    s_add_u32 s46, s46, 8192
    buffer_load_dword v83, v4, s[28:31], s46 offen sc1
    s_add_u32 s46, s46, 8192
    buffer_load_dword v84, v4, s[28:31], s46 offen sc1
    s_add_u32 s46, s46, 8192
    buffer_load_dword v85, v4, s[28:31], s46 offen sc1
    s_add_u32 s46, s46, 8192
    buffer_load_dword v86, v4, s[28:31], s46 offen sc1
    s_add_u32 s46, s46, 8192
    buffer_load_dword v87, v4, s[28:31], s46 offen sc1
    s_add_u32 s46, s46, 8192
    buffer_load_dword v88, v4, s[28:31], s46 offen sc1
    s_add_u32 s46, s46, 8192
    buffer_load_dword v89, v4, s[28:31], s46 offen sc1
    s_add_u32 s46, s46, 8192
    buffer_load_dword v90, v4, s[28:31], s46 offen sc1
    s_add_u32 s46, s46, 8192
    buffer_load_dword v91, v4, s[28:31], s46 offen sc1
    s_add_u32 s46, s46, 8192
    buffer_load_dword v92, v4, s[28:31], s46 offen sc1
    s_add_u32 s46, s46, 8192
    buffer_load_dword v93, v4, s[28:31], s46 offen sc1
    s_add_u32 s46, s46, 8192
    buffer_load_dword v94, v4, s[28:31], s46 offen sc1
    s_add_u32 s46, s46, 8192
    buffer_load_dword v95, v4, s[28:31], s46 offen sc1
    s_waitcnt vmcnt(0)
    v_mov_b32 v6, 0
    v_bitop3_b32 v6, v6, v64, s65 bitop3:0xf6
    v_bitop3_b32 v6, v6, v65, s65 bitop3:0xf6
    v_bitop3_b32 v6, v6, v66, s65 bitop3:0xf6
    v_bitop3_b32 v6, v6, v67, s65 bitop3:0xf6
    v_bitop3_b32 v6, v6, v68, s65 bitop3:0xf6
    v_bitop3_b32 v6, v6, v69, s65 bitop3:0xf6
    v_bitop3_b32 v6, v6, v70, s65 bitop3:0xf6
    v_bitop3_b32 v6, v6, v71, s65 bitop3:0xf6
    v_bitop3_b32 v6, v6, v72, s65 bitop3:0xf6
    v_bitop3_b32 v6, v6, v73, s65 bitop3:0xf6
    v_bitop3_b32 v6, v6, v74, s65 bitop3:0xf6
    v_bitop3_b32 v6, v6, v75, s65 bitop3:0xf6
    v_bitop3_b32 v6, v6, v76, s65 bitop3:0xf6
    v_bitop3_b32 v6, v6, v77, s65 bitop3:0xf6
    v_bitop3_b32 v6, v6, v78, s65 bitop3:0xf6
    v_bitop3_b32 v6, v6, v79, s65 bitop3:0xf6
    v_bitop3_b32 v6, v6, v80, s65 bitop3:0xf6
    v_bitop3_b32 v6, v6, v81, s65 bitop3:0xf6
    v_bitop3_b32 v6, v6, v82, s65 bitop3:0xf6
    v_bitop3_b32 v6, v6, v83, s65 bitop3:0xf6
    v_bitop3_b32 v6, v6, v84, s65 bitop3:0xf6
    v_bitop3_b32 v6, v6, v85, s65 bitop3:0xf6
    v_bitop3_b32 v6, v6, v86, s65 bitop3:0xf6
    v_bitop3_b32 v6, v6, v87, s65 bitop3:0xf6
    v_bitop3_b32 v6, v6, v88, s65 bitop3:0xf6
    v_bitop3_b32 v6, v6, v89, s65 bitop3:0xf6
    v_bitop3_b32 v6, v6, v90, s65 bitop3:0xf6
    v_bitop3_b32 v6, v6, v91, s65 bitop3:0xf6
    v_bitop3_b32 v6, v6, v92, s65 bitop3:0xf6
    v_bitop3_b32 v6, v6, v93, s65 bitop3:0xf6
    v_bitop3_b32 v6, v6, v94, s65 bitop3:0xf6
    v_bitop3_b32 v6, v6, v95, s65 bitop3:0xf6
    v_and_b32 v6, 0xfff, v6
    v_cmp_ne_u32 vcc, 0, v6
    s_nop 1
    s_cmp_eq_u64 vcc, 0
    s_cbranch_scc1 L_p3d_57
    s_sleep 2
    s_sub_u32 s49, s49, 1
    s_cmp_lg_u32 s49, 0
    s_cbranch_scc1 L_p3_56
L_p3d_57:
    v_and_b32 v64, s66, v64
    v_and_b32 v65, s66, v65
    v_and_b32 v66, s66, v66
    v_and_b32 v67, s66, v67
    v_and_b32 v68, s66, v68
    v_and_b32 v69, s66, v69
    v_and_b32 v70, s66, v70
    v_and_b32 v71, s66, v71
    v_and_b32 v72, s66, v72
    v_and_b32 v73, s66, v73
    v_and_b32 v74, s66, v74
    v_and_b32 v75, s66, v75
    v_and_b32 v76, s66, v76
    v_and_b32 v77, s66, v77
    v_and_b32 v78, s66, v78
    v_and_b32 v79, s66, v79
    v_and_b32 v80, s66, v80
    v_and_b32 v81, s66, v81
    v_and_b32 v82, s66, v82
    v_and_b32 v83, s66, v83
    v_and_b32 v84, s66, v84
    v_and_b32 v85, s66, v85
    v_and_b32 v86, s66, v86
    v_and_b32 v87, s66, v87
    v_and_b32 v88, s66, v88
    v_and_b32 v89, s66, v89
    v_and_b32 v90, s66, v90
    v_and_b32 v91, s66, v91
    v_and_b32 v92, s66, v92
    v_and_b32 v93, s66, v93
    v_and_b32 v94, s66, v94
    v_and_b32 v95, s66, v95
    v_add_f32 v64, v64, v80
    v_add_f32 v65, v65, v81
    v_add_f32 v66, v66, v82
    v_add_f32 v67, v67, v83
    v_add_f32 v68, v68, v84
    v_add_f32 v69, v69, v85
    v_add_f32 v70, v70, v86
    v_add_f32 v71, v71, v87
    v_add_f32 v72, v72, v88
    v_add_f32 v73, v73, v89
    v_add_f32 v74, v74, v90
    v_add_f32 v75, v75, v91
    v_add_f32 v76, v76, v92
    v_add_f32 v77, v77, v93
    v_add_f32 v78, v78, v94
    v_add_f32 v79, v79, v95
    v_add_f32 v64, v64, v72
    v_add_f32 v65, v65, v73
    v_add_f32 v66, v66, v74
    v_add_f32 v67, v67, v75
    v_add_f32 v68, v68, v76
    v_add_f32 v69, v69, v77
    v_add_f32 v70, v70, v78
    v_add_f32 v71, v71, v79
    v_add_f32 v64, v64, v68
    v_add_f32 v65, v65, v69
    v_add_f32 v66, v66, v70
    v_add_f32 v67, v67, v71
    v_add_f32 v64, v64, v66
    v_add_f32 v65, v65, v67
    v_add_f32 v64, v64, v65
    v_cvt_pk_bf16_f32 v64, v64, v64
    v_bfe_u32 v2, v0, 2, 2
    v_and_b32 v3, 3, v0
    v_lshl_add_u32 v3, v1, 2, v3
    v_mul_u32_u24 v5, 896, v2
    v_lshl_add_u32 v5, v3, 4, v5
    s_lshr_b32 s45, s44, 3
    s_mul_i32 s45, s45, 224
    s_and_b32 s46, s44, 7
    s_lshl_b32 s46, s46, 1
    s_add_u32 s45, s45, s46
    s_mul_i32 s46, s42, 3584
    s_add_u32 s45, s45, s46
    s_mov_b32 s36, s14
    s_mov_b32 s37, s15
    s_mov_b32 s38, 28672
    s_mov_b32 s39, 0x20000
    v_cmp_gt_u32 vcc, 14, v3
    s_and_saveexec_b64 s[46:47], vcc
    buffer_store_short v64, v5, s[36:39], s45 offen
    s_mov_b64 exec, s[46:47]
L_fin:
L_end:
    s_endpgm
.section .rodata,"a"
.p2align 6
.amdhsa_kernel standalone__gqa_block_cached__sampling_kernel
  .amdhsa_next_free_vgpr 512
  .amdhsa_next_free_sgpr 102
  .amdhsa_accum_offset 256
  .amdhsa_group_segment_fixed_size 0
  .amdhsa_kernarg_size 64
  .amdhsa_user_sgpr_count 2
  .amdhsa_user_sgpr_kernarg_segment_ptr 1
  .amdhsa_system_sgpr_workgroup_id_x 1
  .amdhsa_float_denorm_mode_32 3
.end_amdhsa_kernel
```
